```python
import torch

def _softmax(x, axis=-1):
    return torch.softmax(x, dim=axis)

def _gelu(x):
    return torch.nn.functional.gelu(x, approximate='tanh')

def _silu(x):
    return torch.nn.functional.silu(x)

def _sigmoid(x):
    return torch.sigmoid(x)

def _layernorm(x, axis=-1, eps=1e-05):
    m = x.mean(dim=axis, keepdim=True)
    v = x.var(dim=axis, keepdim=True, unbiased=False)
    return (x - m) / torch.sqrt(v + eps)

def _scatter_add(tgt, idx, src, axis=0):
    return tgt.clone().index_add_(axis, idx, src)

def _segment_sum(src, seg, n):
    out = torch.zeros((n,) + src.shape[1:], dtype=src.dtype)
    return out.index_add_(0, seg, src)

def _pad(x, pw):
    flat = tuple((v for pair in reversed(pw) for v in pair))
    return torch.nn.functional.pad(x, flat)
kernel_name = 'standalone__autoregressive_conv_wavernn__speech'

def setup_inputs():

    _w = lambda a: (lambda t: t.to(torch.bfloat16) if t.is_floating_point() else t)(torch.as_tensor(a))
    B, T, D, K = (2, 4000, 512, 3)
    return {'x': _w((lambda *s: torch.randn(*s, dtype=torch.bfloat16) * 0.05)(B, T, D)), 'w': _w((lambda *s: torch.randn(*s, dtype=torch.bfloat16) * 0.05)(K, D, 2 * D))}

def reference(x, w):
    B, T, D = x.shape
    K = w.shape[0]
    dil = 2
    pad = (K - 1) * dil
    xp = _pad(x, ((0, 0), (pad, 0), (0, 0)))
    h = torch.einsum('btd,de->bte', xp[:, 0:T, :], w[0])
    for i in range(1, K):
        h = h + torch.einsum('btd,de->bte', xp[:, i * dil:i * dil + T, :], w[i])
    f, g = (h[..., :D].clone(), h[..., D:].clone())
    return torch.tanh(f) * _sigmoid(g)
```

```asm
; @launch grid=(256,1,1) block=(256,1,1) lds=163840
.amdgcn_target "amdgcn-amd-amdhsa--gfx950"
.text
.globl standalone__autoregressive_conv_wavernn__speech_kernel
.p2align 12
.p2align 8
.type standalone__autoregressive_conv_wavernn__speech_kernel,@function
standalone__autoregressive_conv_wavernn__speech_kernel:
    s_load_dwordx2 s[42:43], s[0:1], 0
    s_load_dwordx2 s[46:47], s[0:1], 8
    s_load_dwordx2 s[8:9], s[0:1], 16
    s_cmpk_ge_u32 s2, 256
    s_cbranch_scc1 L_end
    s_getpc_b64 s[4:5]
L_pc:
    s_bfe_u32 s6, s2, 196611
    s_lshl_b32 s6, s6, 12
    v_lshl_add_u32 v18, v0, 4, s6
    v_min_u32 v18, L_text_end-4-L_pc, v18
    v_add_co_u32 v18, s[6:7], s4, v18
    v_mov_b32 v19, s5
    s_nop 0
    v_addc_co_u32 v19, s[6:7], 0, v19, s[6:7]
    global_load_dword v11, v[18:19], off
    v_lshrrev_b32 v14, 6, v0
    v_and_b32 v0, 63, v0
    v_readfirstlane_b32 s24, v14
    s_bfe_u32 s25, s2, 0x20001
    s_lshr_b32 s34, s2, 5
    s_lshl3_add_u32 s25, s25, s34
    s_mul_i32 s27, s25, 250
    s_lshl_b32 s52, s2, 2
    s_lshr_b32 s52, 0x66441100, s52
    s_and_b32 s52, s52, 7
    s_lshl_b32 s52, s52, 17
    v_bfe_u32 v12, v0, 3, 1
    v_lshrrev_b32 v15, 4, v0
    v_lshlrev_b32 v13, 4, v0
    v_lshl_add_u32 v12, v12, 2, v15
    v_and_b32 v13, 0x70, v13
    s_bfe_u32 s36, s2, 65540
    s_lshl1_add_u32 s36, s24, s36
    s_lshl_b32 s34, s36, 5
    s_add_u32 s35, s34, s27
    s_and_b32 s34, s34, 0x60
    s_lshl_b32 s35, s35, 10
    s_sub_u32 s35, s35, 4096
    v_xor_b32 v14, s34, v13
    v_lshl_add_u32 v12, v12, 12, v14
    s_and_b32 s37, s25, 15
    s_or_b32 s3, s37, s36
    s_cselect_b64 vcc, 0, 0xff
    v_add_u32 v12, s35, v12
    v_bfrev_b32 v16, 1
    s_lshl_b32 s74, s36, 12
    v_cndmask_b32 v252, v12, v16, vcc
    s_lshr_b32 s32, s52, 10
    s_mov_b32 s14, 8191104
    s_mov_b32 s15, 0x20000
    v_and_b32 v15, 1, v15
    s_and_b32 s34, s24, 1
    v_lshl_or_b32 v15, v15, 1, s34
    v_lshlrev_b32 v15, 5, v15
    v_lshrrev_b32 v14, 3, v0
    v_xor_b32 v13, v13, v15
    s_bfe_u32 s34, s2, 0x20003
    s_and_b32 s26, s2, 1
    s_lshl2_add_u32 s26, s26, s34
    v_lshl_add_u32 v13, v14, 11, v13
    s_lshl_b32 s34, s24, 7
    s_add_u32 s34, s34, s26
    s_lshl_b32 s34, s34, 7
    v_add_u32 v10, s34, v13
    s_mov_b32 s18, 0x10000
    s_mov_b32 s19, s15
    s_lshr_b32 s34, s2, 4
    s_and_b32 s34, s34, 14
    s_lshr_b32 s10, 0x24924, s34
    s_lshl_b32 s11, s24, 11
    s_bitset1_b32 s11, 16
    s_bfe_u32 s34, s10, 131072
    s_lshl_b32 s68, s34, 20
    s_lshl_b32 s34, s34, 13
    s_add_u32 s71, s34, s11
    s_waitcnt lgkmcnt(0)
    s_mov_b32 m0, s74
    s_add_u32 s12, s42, s32
    s_addc_u32 s13, s43, 0
    buffer_load_dwordx4 v252, s[12:15], 0 offen offset:0 lds
    buffer_load_dwordx4 v252, s[12:15], 0 offen offset:1024 lds
    s_add_u32 s68, s68, s46
    s_addc_u32 s28, s47, 0
    s_mov_b32 m0, s71
    s_add_u32 s16, s68, s52
    s_addc_u32 s17, s28, 0
    buffer_load_dwordx4 v10, s[16:19], 0 offen offset:0 lds
    buffer_load_dwordx4 v10, s[16:19], 0 offen offset:1024 lds
    s_xor_b32 s76, s74, 4096
    s_sub_u32 s34, s76, s74
    s_lshl_b32 s34, s34, 3
    s_or_b32 s3, s37, s76
    s_cselect_b64 vcc, 0, 0xff
    v_xor_b32 v14, 32, v12
    v_add_u32 v14, s34, v14
    v_cndmask_b32 v254, v14, v16, vcc
    s_mov_b32 m0, s76
    s_nop 0
    buffer_load_dwordx4 v254, s[12:15], 0 offen offset:0 lds
    buffer_load_dwordx4 v254, s[12:15], 0 offen offset:1024 lds
    s_bfe_u32 s34, s10, 131074
    s_lshl_b32 s69, s34, 20
    s_lshl_b32 s34, s34, 13
    s_add_u32 s72, s34, s11
    s_add_u32 s69, s69, s46
    s_addc_u32 s29, s47, 0
    s_mov_b32 m0, s72
    s_add_u32 s16, s69, s52
    s_addc_u32 s17, s29, 0
    buffer_load_dwordx4 v10, s[16:19], 0 offen offset:0 lds
    buffer_load_dwordx4 v10, s[16:19], 0 offen offset:1024 lds
    s_bfe_u32 s34, s10, 131076
    s_lshl_b32 s70, s34, 20
    s_lshl_b32 s34, s34, 13
    s_add_u32 s73, s34, s11
    s_add_u32 s70, s70, s46
    s_addc_u32 s31, s47, 0
    s_mov_b32 m0, s73
    s_add_u32 s16, s70, s52
    s_addc_u32 s17, s31, 0
    buffer_load_dwordx4 v10, s[16:19], 0 offen offset:0 lds
    buffer_load_dwordx4 v10, s[16:19], 0 offen offset:1024 lds
    s_add_u32 s53, s52, 0x10000
    s_add_u32 s54, s52, 0x20000
    s_and_b32 s54, s54, 0xfffff
    s_add_u32 s75, s74, 2048
    v_add_u32 v253, 2048, v252
    s_add_u32 s77, s76, 2048
    v_add_u32 v255, 2048, v254
    s_mov_b32 s34, 0x10000
    s_mov_b32 s35, 0xfffff
    s_add_u32 s55, s54, s34
    s_add_u32 s56, s55, s34
    s_and_b32 s56, s56, s35
    s_add_u32 s57, s56, s34
    s_add_u32 s58, s57, s34
    s_and_b32 s58, s58, s35
    s_add_u32 s59, s58, s34
    s_add_u32 s60, s59, s34
    s_and_b32 s60, s60, s35
    s_add_u32 s61, s60, s34
    s_add_u32 s62, s61, s34
    s_and_b32 s62, s62, s35
    s_add_u32 s63, s62, s34
    s_add_u32 s64, s63, s34
    s_and_b32 s64, s64, s35
    s_add_u32 s65, s64, s34
    s_add_u32 s66, s65, s34
    s_and_b32 s66, s66, s35
    s_add_u32 s67, s66, s34
    s_lshr_b32 s4, s34, 1
    s_movk_i32 s5, 24576
    s_lshl_b32 s6, s5, 1
    s_add_u32 s7, s6, s5
    s_lshr_b32 s34, s24, 1
    s_and_b32 s35, s24, 1
    v_bfe_u32 v12, v0, 3, 1
    v_bfe_u32 v13, v0, 2, 1
    v_xor_b32 v13, v13, v12
    v_and_b32 v14, 3, v0
    v_lshl_add_u32 v12, v12, 2, v14
    v_lshrrev_b32 v14, 4, v0
    s_lshl_b32 s37, s34, 14
    v_lshl_add_u32 v15, v13, 10, s37
    v_and_b32 v17, 6, v12
    v_xor_b32 v17, v17, v14
    v_lshl_add_u32 v1, v17, 4, v15
    v_and_b32 v17, 1, v12
    v_lshl_add_u32 v1, v17, 7, v1
    v_lshrrev_b32 v17, 1, v12
    v_lshl_add_u32 v1, v17, 12, v1
    v_xor_b32 v2, 64, v1
    v_add_u32 v16, 1, v12
    v_and_b32 v17, 6, v16
    v_xor_b32 v17, v17, v14
    v_lshl_add_u32 v3, v17, 4, v15
    v_and_b32 v17, 1, v16
    v_lshl_add_u32 v3, v17, 7, v3
    v_lshrrev_b32 v17, 1, v16
    v_lshl_add_u32 v3, v17, 12, v3
    v_xor_b32 v4, 64, v3
    s_cmp_eq_u32 s34, 1
    s_cselect_b32 vcc_lo, 0x88008800, 0
    s_mov_b32 vcc_hi, vcc_lo
    v_subrev_u32 v17, 3200, v3
    v_cndmask_b32 v20, v3, v17, vcc
    v_subrev_u32 v17, 1152, v3
    v_cndmask_b32 v3, v3, v17, vcc
    v_xor_b32 v4, 64, v3
    v_bfrev_b32 v17, 1
    s_mov_b32 vcc_lo, 0
    s_cmpk_eq_u32 s75, 30720
    s_cselect_b32 vcc_hi, 0xff000000, 0
    v_cndmask_b32 v253, v253, v17, vcc
    s_cmpk_eq_u32 s77, 30720
    s_cselect_b32 vcc_hi, 0xff000000, 0
    v_cndmask_b32 v255, v255, v17, vcc
    v_lshl_add_u32 v15, v12, 4, v13
    v_lshlrev_b32 v9, 10, v15
    v_and_b32 v16, 1, v14
    v_lshl_add_u32 v9, v16, 5, v9
    v_lshrrev_b32 v17, 1, v14
    v_lshl_add_u32 v9, v17, 4, v9
    s_lshl1_add_u32 s37, s26, s35
    s_lshl_b32 s37, s37, 6
    s_lshl_b32 s36, s34, 17
    s_add_u32 s37, s37, s36
    v_add_u32 v9, s37, v9
    v_bfe_u32 v12, v0, 2, 2
    v_lshlrev_b32 v13, 11, v14
    v_lshl_add_u32 v13, v12, 7, v13
    v_and_b32 v15, 3, v0
    v_lshl_add_u32 v13, v15, 3, v13
    v_add_u32 v13, 65536, v13
    v_and_or_b32 v12, v12, 2, v16
    s_lshl_b32 s37, s35, 1
    v_xor_b32 v12, s37, v12
    v_lshl_add_u32 v5, v12, 5, v13
    v_xor_b32 v7, 32, v5
    v_add_u32 v6, s6, v5
    v_add_u32 v8, s6, v7
    v_add_u32 v12, 4096, v9
    v_add_u32 v13, 8192, v9
    v_add_u32 v14, 12288, v9
    v_mov_b32 v16, v20
    v_xor_b32 v17, 64, v20
    v_mov_b32 v240, 0x40accccd
    v_mov_b32 v241, v240
    v_mov_b32 v242, v240
    v_mov_b32 v243, v240
    v_mov_b32 v19, 0x40f94c36
    s_lshl_b32 s37, s27, 10
    s_add_u32 s20, s8, s37
    s_addc_u32 s21, s9, 0
    s_mov_b32 s22, 256000
    s_mov_b32 s23, s15
    s_mov_b32 s38, 0xc038aa3b
    s_mov_b32 s39, s38
    s_mov_b32 s48, 0xbfb8aa3b
    s_mov_b32 s49, s48
    s_mov_b32 s33, 0x41f00000
    s_mov_b32 m0, s75
    s_nop 0
    buffer_load_dwordx4 v253, s[12:15], 0 offen offset:0 lds
    buffer_load_dwordx4 v253, s[12:15], 0 offen offset:1024 lds
    s_mov_b32 m0, s77
    s_nop 0
    buffer_load_dwordx4 v255, s[12:15], 0 offen offset:0 lds
    buffer_load_dwordx4 v255, s[12:15], 0 offen offset:1024 lds
    s_add_u32 m0, s71, s5
    s_add_u32 s16, s68, s53
    s_addc_u32 s17, s28, 0
    buffer_load_dwordx4 v10, s[16:19], 0 offen offset:0 lds
    buffer_load_dwordx4 v10, s[16:19], 0 offen offset:1024 lds
    s_mov_b32 s30, 1
    s_cmp_eq_u32 s24, 0
    s_cbranch_scc1 L_pg0
    s_cmp_eq_u32 s24, 1
    s_cbranch_scc1 L_pg1
    s_cmp_eq_u32 s24, 2
    s_cbranch_scc1 L_pg2
    s_branch L_pg3
.p2alignl 12, 0xbf810000
L_warm_ret:
    s_mov_b32 s30, 0
    s_waitcnt vmcnt(6)
    s_barrier
    ds_read_b128 v[148:151], v1 offset:0
    ds_read_b64_tr_b16 a[24:25], v5 offset:1024
    ds_read_b64_tr_b16 a[26:27], v5 offset:1536
    ds_read_b128 v[156:159], v1 offset:256
    ds_read_b64_tr_b16 a[32:33], v5 offset:17408
    ds_read_b64_tr_b16 a[34:35], v5 offset:17920
    ds_read_b64_tr_b16 a[28:29], v5 offset:9216
    ds_read_b64_tr_b16 a[30:31], v5 offset:9728
    ds_read_b128 v[164:167], v1 offset:512
    ds_read2_b64 v[232:235], v5 offset1:64
    ds_read_b128 v[172:175], v1 offset:768
    ds_read_b128 v[180:183], v3 offset:0
    ds_read_b64_tr_b16 a[42:43], v7 offset:9728
    ds_read_b64_tr_b16 a[40:41], v7 offset:9216
    s_waitcnt lgkmcnt(11)
    v_mfma_f32_16x16x32_bf16 v[28:31], a[24:27], v[148:151], v[240:243]
    s_waitcnt lgkmcnt(8)
    ds_read_b64_tr_b16 a[38:39], v7 offset:1536
    s_add_u32 m0, s72, s5
    v_mfma_f32_16x16x32_bf16 v[28:31], a[32:35], v[156:159], v[28:31]
    s_waitcnt lgkmcnt(7)
    ds_read_b64_tr_b16 a[36:37], v7 offset:1024
    v_mfma_f32_16x16x32_bf16 v[44:47], a[28:31], v[156:159], v[240:243]
    s_waitcnt lgkmcnt(7)
    ds_read_b64_tr_b16 a[46:47], v7 offset:17920
    v_mfma_f32_16x16x32_bf16 v[60:63], a[32:35], v[164:167], v[240:243]
    s_add_u32 s16, s69, s53
    s_addc_u32 s17, s29, 0
    ds_read_b64_tr_b16 a[44:45], v7 offset:17408
    v_mfma_f32_16x16x32_bf16 v[60:63], a[24:27], v[156:159], v[60:63]
    buffer_load_dwordx4 v10, s[16:19], 0 offen offset:0 lds
    v_mfma_f32_16x16x32_bf16 v[76:79], a[28:31], v[164:167], v[240:243]
    v_mfma_f32_16x16x32_bf16 v[92:95], a[24:27], v[164:167], v[240:243]
    s_waitcnt lgkmcnt(7)
    v_max3_f32 v236, |v148|, |v149|, |v150|
    v_max3_f32 v232, |v232|, |v233|, |v234|
    v_mfma_f32_16x16x32_bf16 v[92:95], a[32:35], v[172:175], v[92:95]
    v_max3_f32 v236, v236, |v156|, |v157|
    v_mul_f32 v232, 0x44000000, v232
    v_mfma_f32_16x16x32_bf16 v[108:111], a[28:31], v[172:175], v[240:243]
    s_waitcnt lgkmcnt(6)
    v_mfma_f32_16x16x32_bf16 v[124:127], a[32:35], v[180:183], v[240:243]
    ds_read_b64_tr_b16 a[2:3], v5 offset:512
    v_mul_f32 v232, v232, v236
    v_mfma_f32_16x16x32_bf16 v[124:127], a[24:27], v[172:175], v[124:127]
    buffer_load_dwordx4 v10, s[16:19], 0 offen offset:1024 lds
    v_mfma_f32_16x16x32_bf16 v[140:143], a[28:31], v[180:183], v[240:243]
    s_waitcnt lgkmcnt(1)
    ds_read_b64_tr_b16 a[0:1], v5 offset:0
    s_add_u32 m0, s73, s5
    v_mfma_f32_16x16x32_bf16 v[144:147], a[40:43], v[180:183], v[240:243]
    s_add_u32 s16, s70, s53
    s_addc_u32 s17, s31, 0
    ds_read_b64_tr_b16 a[10:11], v5 offset:16896
    v_mfma_f32_16x16x32_bf16 v[128:131], a[36:39], v[172:175], v[240:243]
    ds_read_b64_tr_b16 a[8:9], v5 offset:16384
    v_mfma_f32_16x16x32_bf16 v[128:131], a[44:47], v[180:183], v[128:131]
    ds_read_b64_tr_b16 a[6:7], v5 offset:8704
    v_min_f32 v228, 0x3eb33333, v232
    v_mfma_f32_16x16x32_bf16 v[112:115], a[40:43], v[172:175], v[240:243]
    ds_read_b64_tr_b16 a[4:5], v5 offset:8192
    v_mfma_f32_16x16x32_bf16 v[96:99], a[44:47], v[172:175], v[240:243]
    buffer_load_dwordx4 v10, s[16:19], 0 offen offset:0 lds
    v_mfma_f32_16x16x32_bf16 v[96:99], a[36:39], v[164:167], v[96:99]
    v_mov_b32 v229, v228
    v_mov_b32 v230, v228
    v_mfma_f32_16x16x32_bf16 v[80:83], a[40:43], v[164:167], v[240:243]
    v_mov_b32 v231, v228
    v_mul_f32 v18, s38, v228
    v_mfma_f32_16x16x32_bf16 v[64:67], a[36:39], v[156:159], v[240:243]
    v_mfma_f32_16x16x32_bf16 v[64:67], a[44:47], v[164:167], v[64:67]
    v_mfma_f32_16x16x32_bf16 v[48:51], a[40:43], v[156:159], v[240:243]
    ds_read_b64_tr_b16 a[18:19], v7 offset:8704
    v_mfma_f32_16x16x32_bf16 v[32:35], a[44:47], v[156:159], v[240:243]
    buffer_load_dwordx4 v10, s[16:19], 0 offen offset:1024 lds
    v_mfma_f32_16x16x32_bf16 v[32:35], a[36:39], v[148:151], v[32:35]
    s_waitcnt lgkmcnt(1)
    ds_read_b64_tr_b16 a[16:17], v7 offset:8192
    s_add_u32 m0, s74, s4
    v_mfma_f32_16x16x32_bf16 v[20:23], a[0:3], v[148:151], v[228:231]
    s_lshr_b32 s32, s54, 10
    ds_read_b64_tr_b16 a[14:15], v7 offset:512
    v_mfma_f32_16x16x32_bf16 v[20:23], a[8:11], v[156:159], v[20:23]
    s_add_u32 s12, s42, s32
    s_addc_u32 s13, s43, 0
    ds_read_b64_tr_b16 a[12:13], v7 offset:0
    v_mfma_f32_16x16x32_bf16 v[36:39], a[4:7], v[156:159], v[228:231]
    ds_read_b64_tr_b16 a[22:23], v7 offset:16896
    v_mfma_f32_16x16x32_bf16 v[52:55], a[8:11], v[164:167], v[228:231]
    ds_read_b64_tr_b16 a[20:21], v7 offset:16384
    v_mfma_f32_16x16x32_bf16 v[52:55], a[0:3], v[156:159], v[52:55]
    buffer_load_dwordx4 v252, s[12:15], 0 offen offset:0 lds
    v_mfma_f32_16x16x32_bf16 v[68:71], a[4:7], v[164:167], v[228:231]
    v_mfma_f32_16x16x32_bf16 v[84:87], a[0:3], v[164:167], v[228:231]
    v_mfma_f32_16x16x32_bf16 v[84:87], a[8:11], v[172:175], v[84:87]
    v_mfma_f32_16x16x32_bf16 v[100:103], a[4:7], v[172:175], v[228:231]
    v_mfma_f32_16x16x32_bf16 v[116:119], a[8:11], v[180:183], v[228:231]
    v_mfma_f32_16x16x32_bf16 v[116:119], a[0:3], v[172:175], v[116:119]
    buffer_load_dwordx4 v252, s[12:15], 0 offen offset:1024 lds
    v_mfma_f32_16x16x32_bf16 v[132:135], a[4:7], v[180:183], v[228:231]
    s_waitcnt lgkmcnt(0)
    s_add_u32 m0, s75, s4
    v_mfma_f32_16x16x32_bf16 v[136:139], a[16:19], v[180:183], v[228:231]
    s_waitcnt vmcnt(8)
    s_barrier
    v_mfma_f32_16x16x32_bf16 v[120:123], a[12:15], v[172:175], v[228:231]
    v_mfma_f32_16x16x32_bf16 v[120:123], a[20:23], v[180:183], v[120:123]
    ds_read_b128 v[152:155], v1 offset:2048
    v_mfma_f32_16x16x32_bf16 v[104:107], a[16:19], v[172:175], v[228:231]
    ds_read_b128 v[160:163], v1 offset:2304
    v_mfma_f32_16x16x32_bf16 v[88:91], a[20:23], v[172:175], v[228:231]
    buffer_load_dwordx4 v253, s[12:15], 0 offen offset:0 lds
    v_mfma_f32_16x16x32_bf16 v[88:91], a[12:15], v[164:167], v[88:91]
    v_mfma_f32_16x16x32_bf16 v[72:75], a[16:19], v[164:167], v[228:231]
    ds_read_b128 v[168:171], v1 offset:2560
    v_mfma_f32_16x16x32_bf16 v[56:59], a[12:15], v[156:159], v[228:231]
    v_mfma_f32_16x16x32_bf16 v[56:59], a[20:23], v[164:167], v[56:59]
    v_mfma_f32_16x16x32_bf16 v[40:43], a[16:19], v[156:159], v[228:231]
    ds_read_b128 v[176:179], v1 offset:2816
    v_mfma_f32_16x16x32_bf16 v[24:27], a[20:23], v[156:159], v[228:231]
    buffer_load_dwordx4 v253, s[12:15], 0 offen offset:1024 lds
    v_mfma_f32_16x16x32_bf16 v[24:27], a[12:15], v[148:151], v[24:27]
    s_waitcnt lgkmcnt(2)
    s_add_u32 m0, s76, s4
    v_mfma_f32_16x16x32_bf16 v[20:23], a[4:7], v[152:155], v[20:23]
    ds_read_b128 v[184:187], v16 offset:2048
    v_mfma_f32_16x16x32_bf16 v[36:39], a[0:3], v[152:155], v[36:39]
    v_mfma_f32_16x16x32_bf16 v[36:39], a[8:11], v[160:163], v[36:39]
    v_mfma_f32_16x16x32_bf16 v[52:55], a[4:7], v[160:163], v[52:55]
    s_waitcnt lgkmcnt(2)
    v_mfma_f32_16x16x32_bf16 v[68:71], a[8:11], v[168:171], v[68:71]
    buffer_load_dwordx4 v254, s[12:15], 0 offen offset:0 lds
    v_mfma_f32_16x16x32_bf16 v[68:71], a[0:3], v[160:163], v[68:71]
    v_mfma_f32_16x16x32_bf16 v[84:87], a[4:7], v[168:171], v[84:87]
    v_mfma_f32_16x16x32_bf16 v[100:103], a[0:3], v[168:171], v[100:103]
    s_waitcnt lgkmcnt(0)
    v_mfma_f32_16x16x32_bf16 v[100:103], a[8:11], v[176:179], v[100:103]
    ds_read_b128 v[188:191], v2 offset:0
    v_mfma_f32_16x16x32_bf16 v[116:119], a[4:7], v[176:179], v[116:119]
    ds_read_b128 v[196:199], v2 offset:256
    v_mfma_f32_16x16x32_bf16 v[132:135], a[8:11], v[184:187], v[132:135]
    buffer_load_dwordx4 v254, s[12:15], 0 offen offset:1024 lds
    v_mfma_f32_16x16x32_bf16 v[132:135], a[0:3], v[176:179], v[132:135]
    s_add_u32 m0, s77, s4
    ds_read_b128 v[204:207], v2 offset:512
    v_mfma_f32_16x16x32_bf16 v[136:139], a[12:15], v[176:179], v[136:139]
    ds_read_b128 v[212:215], v2 offset:768
    v_mfma_f32_16x16x32_bf16 v[136:139], a[20:23], v[184:187], v[136:139]
    ds_read_b128 v[220:223], v4 offset:0
    v_mfma_f32_16x16x32_bf16 v[120:123], a[16:19], v[176:179], v[120:123]
    ds_read_b128 v[192:195], v2 offset:2048
    v_mfma_f32_16x16x32_bf16 v[104:107], a[20:23], v[176:179], v[104:107]
    ds_read_b128 v[200:203], v2 offset:2304
    v_mfma_f32_16x16x32_bf16 v[104:107], a[12:15], v[168:171], v[104:107]
    buffer_load_dwordx4 v255, s[12:15], 0 offen offset:0 lds
    v_mfma_f32_16x16x32_bf16 v[88:91], a[16:19], v[168:171], v[88:91]
    ds_read_b128 v[208:211], v2 offset:2560
    v_mfma_f32_16x16x32_bf16 v[72:75], a[12:15], v[160:163], v[72:75]
    ds_read_b128 v[216:219], v2 offset:2816
    v_mfma_f32_16x16x32_bf16 v[72:75], a[20:23], v[168:171], v[72:75]
    ds_read_b128 v[224:227], v17 offset:2048
    v_mfma_f32_16x16x32_bf16 v[56:59], a[16:19], v[160:163], v[56:59]
    v_mfma_f32_16x16x32_bf16 v[40:43], a[20:23], v[160:163], v[40:43]
    v_mfma_f32_16x16x32_bf16 v[40:43], a[12:15], v[152:155], v[40:43]
    buffer_load_dwordx4 v255, s[12:15], 0 offen offset:1024 lds
    v_mfma_f32_16x16x32_bf16 v[24:27], a[16:19], v[152:155], v[24:27]
    s_add_u32 m0, s71, s6
    s_add_u32 s16, s68, s54
    s_addc_u32 s17, s28, 0
    v_mfma_f32_16x16x32_bf16 v[28:31], a[28:31], v[152:155], v[28:31]
    v_mfma_f32_16x16x32_bf16 v[44:47], a[24:27], v[152:155], v[44:47]
    v_mfma_f32_16x16x32_bf16 v[44:47], a[32:35], v[160:163], v[44:47]
    v_mfma_f32_16x16x32_bf16 v[60:63], a[28:31], v[160:163], v[60:63]
    v_mfma_f32_16x16x32_bf16 v[76:79], a[32:35], v[168:171], v[76:79]
    s_waitcnt vmcnt(8) lgkmcnt(0)
    s_barrier
    v_mfma_f32_16x16x32_bf16 v[76:79], a[24:27], v[160:163], v[76:79]
    buffer_load_dwordx4 v10, s[16:19], 0 offen offset:0 lds
    v_mfma_f32_16x16x32_bf16 v[92:95], a[28:31], v[168:171], v[92:95]
    v_mfma_f32_16x16x32_bf16 v[108:111], a[24:27], v[168:171], v[108:111]
    v_mfma_f32_16x16x32_bf16 v[108:111], a[32:35], v[176:179], v[108:111]
    v_mfma_f32_16x16x32_bf16 v[124:127], a[28:31], v[176:179], v[124:127]
    ds_read_b64_tr_b16 a[50:51], v5 offset:25088
    v_mfma_f32_16x16x32_bf16 v[140:143], a[32:35], v[184:187], v[140:143]
    buffer_load_dwordx4 v10, s[16:19], 0 offen offset:1024 lds
    v_mfma_f32_16x16x32_bf16 v[140:143], a[24:27], v[176:179], v[140:143]
    s_add_u32 m0, s72, s6
    ds_read_b64_tr_b16 a[48:49], v5 offset:24576
    v_mfma_f32_16x16x32_bf16 v[144:147], a[36:39], v[176:179], v[144:147]
    s_add_u32 s16, s69, s54
    s_addc_u32 s17, s29, 0
    ds_read_b64_tr_b16 a[54:55], v5 offset:33280
    v_mfma_f32_16x16x32_bf16 v[144:147], a[44:47], v[184:187], v[144:147]
    ds_read_b64_tr_b16 a[52:53], v5 offset:32768
    v_mfma_f32_16x16x32_bf16 v[128:131], a[40:43], v[176:179], v[128:131]
    ds_read_b64_tr_b16 a[58:59], v5 offset:41472
    v_mfma_f32_16x16x32_bf16 v[112:115], a[44:47], v[176:179], v[112:115]
    ds_read_b64_tr_b16 a[56:57], v5 offset:40960
    v_mfma_f32_16x16x32_bf16 v[112:115], a[36:39], v[168:171], v[112:115]
    buffer_load_dwordx4 v10, s[16:19], 0 offen offset:0 lds
    v_mfma_f32_16x16x32_bf16 v[96:99], a[40:43], v[168:171], v[96:99]
    v_mfma_f32_16x16x32_bf16 v[80:83], a[36:39], v[160:163], v[80:83]
    v_mfma_f32_16x16x32_bf16 v[80:83], a[44:47], v[168:171], v[80:83]
    v_mfma_f32_16x16x32_bf16 v[64:67], a[40:43], v[160:163], v[64:67]
    v_mfma_f32_16x16x32_bf16 v[48:51], a[44:47], v[160:163], v[48:51]
    v_mfma_f32_16x16x32_bf16 v[48:51], a[36:39], v[152:155], v[48:51]
    buffer_load_dwordx4 v10, s[16:19], 0 offen offset:1024 lds
    v_mfma_f32_16x16x32_bf16 v[32:35], a[40:43], v[152:155], v[32:35]
    s_waitcnt lgkmcnt(0)
    s_add_u32 m0, s73, s6
    v_mfma_f32_16x16x32_bf16 v[20:23], a[48:51], v[188:191], v[20:23]
    s_add_u32 s16, s70, s54
    s_addc_u32 s17, s31, 0
    v_mfma_f32_16x16x32_bf16 v[20:23], a[52:55], v[192:195], v[20:23]
    v_mfma_f32_16x16x32_bf16 v[20:23], a[56:59], v[196:199], v[20:23]
    v_mfma_f32_16x16x32_bf16 v[36:39], a[56:59], v[200:203], v[36:39]
    v_mfma_f32_16x16x32_bf16 v[36:39], a[52:55], v[196:199], v[36:39]
    buffer_load_dwordx4 v10, s[16:19], 0 offen offset:0 lds
    v_mfma_f32_16x16x32_bf16 v[36:39], a[48:51], v[192:195], v[36:39]
    v_mfma_f32_16x16x32_bf16 v[52:55], a[48:51], v[196:199], v[52:55]
    v_mfma_f32_16x16x32_bf16 v[52:55], a[52:55], v[200:203], v[52:55]
    v_mfma_f32_16x16x32_bf16 v[52:55], a[56:59], v[204:207], v[52:55]
    v_mfma_f32_16x16x32_bf16 v[68:71], a[56:59], v[208:211], v[68:71]
    ds_read_b64_tr_b16 a[62:63], v7 offset:25088
    v_mfma_f32_16x16x32_bf16 v[68:71], a[52:55], v[204:207], v[68:71]
    buffer_load_dwordx4 v10, s[16:19], 0 offen offset:1024 lds
    v_mfma_f32_16x16x32_bf16 v[68:71], a[48:51], v[200:203], v[68:71]
    s_add_u32 m0, s71, s7
    ds_read_b64_tr_b16 a[60:61], v7 offset:24576
    v_mfma_f32_16x16x32_bf16 v[84:87], a[48:51], v[204:207], v[84:87]
    s_add_u32 s16, s68, s55
    s_addc_u32 s17, s28, 0
    ds_read_b64_tr_b16 a[66:67], v7 offset:33280
    v_mfma_f32_16x16x32_bf16 v[84:87], a[52:55], v[208:211], v[84:87]
    ds_read_b64_tr_b16 a[64:65], v7 offset:32768
    v_mfma_f32_16x16x32_bf16 v[84:87], a[56:59], v[212:215], v[84:87]
    ds_read_b64_tr_b16 a[70:71], v7 offset:41472
    v_mfma_f32_16x16x32_bf16 v[100:103], a[56:59], v[216:219], v[100:103]
    ds_read_b64_tr_b16 a[68:69], v7 offset:40960
    v_mfma_f32_16x16x32_bf16 v[100:103], a[52:55], v[212:215], v[100:103]
    buffer_load_dwordx4 v10, s[16:19], 0 offen offset:0 lds
    v_mfma_f32_16x16x32_bf16 v[100:103], a[48:51], v[208:211], v[100:103]
    v_mfma_f32_16x16x32_bf16 v[116:119], a[48:51], v[212:215], v[116:119]
    v_mfma_f32_16x16x32_bf16 v[116:119], a[52:55], v[216:219], v[116:119]
    v_mfma_f32_16x16x32_bf16 v[116:119], a[56:59], v[220:223], v[116:119]
    v_mfma_f32_16x16x32_bf16 v[132:135], a[56:59], v[224:227], v[132:135]
    v_mfma_f32_16x16x32_bf16 v[132:135], a[52:55], v[220:223], v[132:135]
    v_mfma_f32_16x16x32_bf16 v[132:135], a[48:51], v[216:219], v[132:135]
    s_waitcnt lgkmcnt(0)
    v_mfma_f32_16x16x32_bf16 v[136:139], a[60:63], v[216:219], v[136:139]
    v_mfma_f32_16x16x32_bf16 v[136:139], a[64:67], v[220:223], v[136:139]
    buffer_load_dwordx4 v10, s[16:19], 0 offen offset:1024 lds
    v_mfma_f32_16x16x32_bf16 v[136:139], a[68:71], v[224:227], v[136:139]
    s_add_u32 m0, s72, s7
    s_add_u32 s16, s69, s55
    s_addc_u32 s17, s29, 0
    v_mfma_f32_16x16x32_bf16 v[120:123], a[68:71], v[220:223], v[120:123]
    v_mfma_f32_16x16x32_bf16 v[120:123], a[64:67], v[216:219], v[120:123]
    v_mfma_f32_16x16x32_bf16 v[120:123], a[60:63], v[212:215], v[120:123]
    v_mfma_f32_16x16x32_bf16 v[104:107], a[60:63], v[208:211], v[104:107]
    v_mfma_f32_16x16x32_bf16 v[104:107], a[64:67], v[212:215], v[104:107]
    v_mfma_f32_16x16x32_bf16 v[104:107], a[68:71], v[216:219], v[104:107]
    v_mfma_f32_16x16x32_bf16 v[88:91], a[68:71], v[212:215], v[88:91]
    v_mfma_f32_16x16x32_bf16 v[88:91], a[64:67], v[208:211], v[88:91]
    buffer_load_dwordx4 v10, s[16:19], 0 offen offset:0 lds
    v_mfma_f32_16x16x32_bf16 v[88:91], a[60:63], v[204:207], v[88:91]
    ds_read_b64_tr_b16 a[74:75], v5 offset:26112
    v_mfma_f32_16x16x32_bf16 v[72:75], a[60:63], v[200:203], v[72:75]
    ds_read_b64_tr_b16 a[72:73], v5 offset:25600
    v_mfma_f32_16x16x32_bf16 v[72:75], a[64:67], v[204:207], v[72:75]
    ds_read_b64_tr_b16 a[78:79], v5 offset:34304
    v_mfma_f32_16x16x32_bf16 v[72:75], a[68:71], v[208:211], v[72:75]
    ds_read_b64_tr_b16 a[76:77], v5 offset:33792
    v_mfma_f32_16x16x32_bf16 v[56:59], a[68:71], v[204:207], v[56:59]
    ds_read_b64_tr_b16 a[82:83], v5 offset:42496
    v_mfma_f32_16x16x32_bf16 v[56:59], a[64:67], v[200:203], v[56:59]
    ds_read_b64_tr_b16 a[80:81], v5 offset:41984
    v_mfma_f32_16x16x32_bf16 v[56:59], a[60:63], v[196:199], v[56:59]
    v_mfma_f32_16x16x32_bf16 v[40:43], a[60:63], v[192:195], v[40:43]
    v_mfma_f32_16x16x32_bf16 v[40:43], a[64:67], v[196:199], v[40:43]
    buffer_load_dwordx4 v10, s[16:19], 0 offen offset:1024 lds
    v_mfma_f32_16x16x32_bf16 v[40:43], a[68:71], v[200:203], v[40:43]
    s_add_u32 m0, s73, s7
    s_add_u32 s16, s70, s55
    s_addc_u32 s17, s31, 0
    v_mfma_f32_16x16x32_bf16 v[24:27], a[68:71], v[196:199], v[24:27]
    v_mfma_f32_16x16x32_bf16 v[24:27], a[64:67], v[192:195], v[24:27]
    v_mfma_f32_16x16x32_bf16 v[24:27], a[60:63], v[188:191], v[24:27]
    s_waitcnt lgkmcnt(0)
    v_mfma_f32_16x16x32_bf16 v[28:31], a[72:75], v[188:191], v[28:31]
    v_mfma_f32_16x16x32_bf16 v[28:31], a[76:79], v[192:195], v[28:31]
    v_mfma_f32_16x16x32_bf16 v[28:31], a[80:83], v[196:199], v[28:31]
    v_mfma_f32_16x16x32_bf16 v[44:47], a[80:83], v[200:203], v[44:47]
    v_mfma_f32_16x16x32_bf16 v[44:47], a[76:79], v[196:199], v[44:47]
    buffer_load_dwordx4 v10, s[16:19], 0 offen offset:0 lds
    v_mfma_f32_16x16x32_bf16 v[44:47], a[72:75], v[192:195], v[44:47]
    v_mfma_f32_16x16x32_bf16 v[60:63], a[72:75], v[196:199], v[60:63]
    v_mfma_f32_16x16x32_bf16 v[60:63], a[76:79], v[200:203], v[60:63]
    v_mfma_f32_16x16x32_bf16 v[60:63], a[80:83], v[204:207], v[60:63]
    v_mfma_f32_16x16x32_bf16 v[76:79], a[80:83], v[208:211], v[76:79]
    v_mfma_f32_16x16x32_bf16 v[76:79], a[76:79], v[204:207], v[76:79]
    ds_read_b64_tr_b16 a[86:87], v7 offset:26112
    v_mfma_f32_16x16x32_bf16 v[76:79], a[72:75], v[200:203], v[76:79]
    ds_read_b64_tr_b16 a[84:85], v7 offset:25600
    v_mfma_f32_16x16x32_bf16 v[92:95], a[72:75], v[204:207], v[92:95]
    ds_read_b64_tr_b16 a[90:91], v7 offset:34304
    v_mfma_f32_16x16x32_bf16 v[92:95], a[76:79], v[208:211], v[92:95]
    buffer_load_dwordx4 v10, s[16:19], 0 offen offset:1024 lds
    v_mfma_f32_16x16x32_bf16 v[92:95], a[80:83], v[212:215], v[92:95]
    s_mov_b32 m0, s74
    ds_read_b64_tr_b16 a[88:89], v7 offset:33792
    s_lshr_b32 s32, s56, 10
    v_mfma_f32_16x16x32_bf16 v[108:111], a[80:83], v[216:219], v[108:111]
    s_add_u32 s12, s42, s32
    s_addc_u32 s13, s43, 0
    ds_read_b64_tr_b16 a[94:95], v7 offset:42496
    v_mfma_f32_16x16x32_bf16 v[108:111], a[76:79], v[212:215], v[108:111]
    ds_read_b64_tr_b16 a[92:93], v7 offset:41984
    v_mfma_f32_16x16x32_bf16 v[108:111], a[72:75], v[208:211], v[108:111]
    v_mfma_f32_16x16x32_bf16 v[124:127], a[72:75], v[212:215], v[124:127]
    v_mfma_f32_16x16x32_bf16 v[124:127], a[76:79], v[216:219], v[124:127]
    v_mfma_f32_16x16x32_bf16 v[124:127], a[80:83], v[220:223], v[124:127]
    v_mfma_f32_16x16x32_bf16 v[140:143], a[80:83], v[224:227], v[140:143]
    v_mfma_f32_16x16x32_bf16 v[140:143], a[76:79], v[220:223], v[140:143]
    buffer_load_dwordx4 v252, s[12:15], 0 offen offset:0 lds
    v_mfma_f32_16x16x32_bf16 v[140:143], a[72:75], v[216:219], v[140:143]
    s_waitcnt lgkmcnt(0)
    v_mfma_f32_16x16x32_bf16 v[144:147], a[84:87], v[216:219], v[144:147]
    v_mfma_f32_16x16x32_bf16 v[144:147], a[88:91], v[220:223], v[144:147]
    v_mfma_f32_16x16x32_bf16 v[144:147], a[92:95], v[224:227], v[144:147]
    v_mfma_f32_16x16x32_bf16 v[128:131], a[92:95], v[220:223], v[128:131]
    v_mfma_f32_16x16x32_bf16 v[128:131], a[88:91], v[216:219], v[128:131]
    s_waitcnt vmcnt(7)
    s_barrier
    v_mfma_f32_16x16x32_bf16 v[128:131], a[84:87], v[212:215], v[128:131]
    v_mfma_f32_16x16x32_bf16 v[112:115], a[84:87], v[208:211], v[112:115]
    ds_read_b64_tr_b16 a[98:99], v6 offset:512
    v_mfma_f32_16x16x32_bf16 v[112:115], a[88:91], v[212:215], v[112:115]
    buffer_load_dwordx4 v252, s[12:15], 0 offen offset:1024 lds
    v_mfma_f32_16x16x32_bf16 v[112:115], a[92:95], v[216:219], v[112:115]
    s_mov_b32 m0, s75
    ds_read_b64_tr_b16 a[96:97], v6 offset:0
    v_mfma_f32_16x16x32_bf16 v[96:99], a[92:95], v[212:215], v[96:99]
    ds_read_b128 v[148:151], v1 offset:32768
    v_mfma_f32_16x16x32_bf16 v[96:99], a[88:91], v[208:211], v[96:99]
    ds_read_b64_tr_b16 a[102:103], v6 offset:8704
    v_mfma_f32_16x16x32_bf16 v[96:99], a[84:87], v[204:207], v[96:99]
    ds_read_b64_tr_b16 a[100:101], v6 offset:8192
    v_mfma_f32_16x16x32_bf16 v[80:83], a[84:87], v[200:203], v[80:83]
    ds_read_b128 v[152:155], v1 offset:34816
    v_mfma_f32_16x16x32_bf16 v[80:83], a[88:91], v[204:207], v[80:83]
    ds_read_b64_tr_b16 a[106:107], v6 offset:16896
    v_mfma_f32_16x16x32_bf16 v[80:83], a[92:95], v[208:211], v[80:83]
    ds_read_b64_tr_b16 a[104:105], v6 offset:16384
    v_mfma_f32_16x16x32_bf16 v[64:67], a[92:95], v[204:207], v[64:67]
    ds_read_b128 v[156:159], v1 offset:33024
    v_mfma_f32_16x16x32_bf16 v[64:67], a[88:91], v[200:203], v[64:67]
    buffer_load_dwordx4 v253, s[12:15], 0 offen offset:0 lds
    v_mfma_f32_16x16x32_bf16 v[64:67], a[84:87], v[196:199], v[64:67]
    ds_read_b128 v[160:163], v1 offset:35072
    v_mfma_f32_16x16x32_bf16 v[48:51], a[84:87], v[192:195], v[48:51]
    v_mfma_f32_16x16x32_bf16 v[48:51], a[88:91], v[196:199], v[48:51]
    v_mfma_f32_16x16x32_bf16 v[48:51], a[92:95], v[200:203], v[48:51]
    v_mfma_f32_16x16x32_bf16 v[32:35], a[92:95], v[196:199], v[32:35]
    v_mfma_f32_16x16x32_bf16 v[32:35], a[88:91], v[192:195], v[32:35]
    ds_read_b128 v[164:167], v1 offset:33280
    v_mfma_f32_16x16x32_bf16 v[32:35], a[84:87], v[188:191], v[32:35]
    s_waitcnt lgkmcnt(2)
    ds_read_b128 v[168:171], v1 offset:35328
    v_mfma_f32_16x16x32_bf16 v[20:23], a[96:99], v[148:151], v[20:23]
    v_mfma_f32_16x16x32_bf16 v[20:23], a[100:103], v[152:155], v[20:23]
    buffer_load_dwordx4 v253, s[12:15], 0 offen offset:1024 lds
    v_mfma_f32_16x16x32_bf16 v[20:23], a[104:107], v[156:159], v[20:23]
    s_waitcnt lgkmcnt(2)
    s_mov_b32 m0, s76
    v_mfma_f32_16x16x32_bf16 v[36:39], a[104:107], v[160:163], v[36:39]
    v_mfma_f32_16x16x32_bf16 v[36:39], a[100:103], v[156:159], v[36:39]
    ds_read_b128 v[172:175], v1 offset:33536
    v_mfma_f32_16x16x32_bf16 v[36:39], a[96:99], v[152:155], v[36:39]
    ds_read_b128 v[176:179], v1 offset:35584
    v_mfma_f32_16x16x32_bf16 v[52:55], a[96:99], v[156:159], v[52:55]
    v_mfma_f32_16x16x32_bf16 v[52:55], a[100:103], v[160:163], v[52:55]
    s_waitcnt lgkmcnt(2)
    v_mfma_f32_16x16x32_bf16 v[52:55], a[104:107], v[164:167], v[52:55]
    ds_read_b128 v[180:183], v3 offset:32768
    v_mfma_f32_16x16x32_bf16 v[68:71], a[104:107], v[168:171], v[68:71]
    ds_read_b128 v[184:187], v16 offset:34816
    v_mfma_f32_16x16x32_bf16 v[68:71], a[100:103], v[164:167], v[68:71]
    buffer_load_dwordx4 v254, s[12:15], 0 offen offset:0 lds
    v_mfma_f32_16x16x32_bf16 v[68:71], a[96:99], v[160:163], v[68:71]
    ds_read_b64_tr_b16 a[110:111], v8 offset:512
    v_mfma_f32_16x16x32_bf16 v[84:87], a[96:99], v[164:167], v[84:87]
    ds_read_b64_tr_b16 a[108:109], v8 offset:0
    v_mfma_f32_16x16x32_bf16 v[84:87], a[100:103], v[168:171], v[84:87]
    s_waitcnt lgkmcnt(4)
    ds_read_b64_tr_b16 a[114:115], v8 offset:8704
    v_mfma_f32_16x16x32_bf16 v[84:87], a[104:107], v[172:175], v[84:87]
    ds_read_b64_tr_b16 a[112:113], v8 offset:8192
    v_mfma_f32_16x16x32_bf16 v[100:103], a[104:107], v[176:179], v[100:103]
    ds_read_b64_tr_b16 a[118:119], v8 offset:16896
    v_mfma_f32_16x16x32_bf16 v[100:103], a[100:103], v[172:175], v[100:103]
    ds_read_b64_tr_b16 a[116:117], v8 offset:16384
    v_mfma_f32_16x16x32_bf16 v[100:103], a[96:99], v[168:171], v[100:103]
    v_mfma_f32_16x16x32_bf16 v[116:119], a[96:99], v[172:175], v[116:119]
    v_mfma_f32_16x16x32_bf16 v[116:119], a[100:103], v[176:179], v[116:119]
    s_waitcnt lgkmcnt(4)
    buffer_load_dwordx4 v254, s[12:15], 0 offen offset:1024 lds
    v_mfma_f32_16x16x32_bf16 v[116:119], a[104:107], v[180:183], v[116:119]
    s_mov_b32 m0, s77
    v_mfma_f32_16x16x32_bf16 v[132:135], a[104:107], v[184:187], v[132:135]
    v_mfma_f32_16x16x32_bf16 v[132:135], a[100:103], v[180:183], v[132:135]
    v_mfma_f32_16x16x32_bf16 v[132:135], a[96:99], v[176:179], v[132:135]
    v_mfma_f32_16x16x32_bf16 v[136:139], a[108:111], v[176:179], v[136:139]
    s_waitcnt lgkmcnt(0)
    v_mfma_f32_16x16x32_bf16 v[136:139], a[112:115], v[180:183], v[136:139]
    v_mfma_f32_16x16x32_bf16 v[136:139], a[116:119], v[184:187], v[136:139]
    v_mfma_f32_16x16x32_bf16 v[120:123], a[116:119], v[180:183], v[120:123]
    v_mfma_f32_16x16x32_bf16 v[120:123], a[112:115], v[176:179], v[120:123]
    buffer_load_dwordx4 v255, s[12:15], 0 offen offset:0 lds
    v_mfma_f32_16x16x32_bf16 v[120:123], a[108:111], v[172:175], v[120:123]
    v_mfma_f32_16x16x32_bf16 v[104:107], a[108:111], v[168:171], v[104:107]
    v_mfma_f32_16x16x32_bf16 v[104:107], a[112:115], v[172:175], v[104:107]
    v_mfma_f32_16x16x32_bf16 v[104:107], a[116:119], v[176:179], v[104:107]
    v_mfma_f32_16x16x32_bf16 v[88:91], a[116:119], v[172:175], v[88:91]
    v_mfma_f32_16x16x32_bf16 v[88:91], a[112:115], v[168:171], v[88:91]
    ds_read_b64_tr_b16 a[122:123], v6 offset:1536
    v_mfma_f32_16x16x32_bf16 v[88:91], a[108:111], v[164:167], v[88:91]
    ds_read_b64_tr_b16 a[120:121], v6 offset:1024
    v_mfma_f32_16x16x32_bf16 v[72:75], a[108:111], v[160:163], v[72:75]
    ds_read_b64_tr_b16 a[126:127], v6 offset:9728
    v_mfma_f32_16x16x32_bf16 v[72:75], a[112:115], v[164:167], v[72:75]
    buffer_load_dwordx4 v255, s[12:15], 0 offen offset:1024 lds
    v_mfma_f32_16x16x32_bf16 v[72:75], a[116:119], v[168:171], v[72:75]
    s_mov_b32 m0, s71
    ds_read_b64_tr_b16 a[124:125], v6 offset:9216
    v_mfma_f32_16x16x32_bf16 v[56:59], a[116:119], v[164:167], v[56:59]
    s_add_u32 s16, s68, s56
    s_addc_u32 s17, s28, 0
    ds_read_b64_tr_b16 a[130:131], v6 offset:17920
    v_mfma_f32_16x16x32_bf16 v[56:59], a[112:115], v[160:163], v[56:59]
    ds_read_b64_tr_b16 a[128:129], v6 offset:17408
    v_mfma_f32_16x16x32_bf16 v[56:59], a[108:111], v[156:159], v[56:59]
    v_mfma_f32_16x16x32_bf16 v[40:43], a[108:111], v[152:155], v[40:43]
    v_mfma_f32_16x16x32_bf16 v[40:43], a[112:115], v[156:159], v[40:43]
    v_mfma_f32_16x16x32_bf16 v[40:43], a[116:119], v[160:163], v[40:43]
    v_mfma_f32_16x16x32_bf16 v[24:27], a[116:119], v[156:159], v[24:27]
    v_mfma_f32_16x16x32_bf16 v[24:27], a[112:115], v[152:155], v[24:27]
    buffer_load_dwordx4 v10, s[16:19], 0 offen offset:0 lds
    v_mfma_f32_16x16x32_bf16 v[24:27], a[108:111], v[148:151], v[24:27]
    s_waitcnt lgkmcnt(0)
    v_mfma_f32_16x16x32_bf16 v[28:31], a[120:123], v[148:151], v[28:31]
    v_mfma_f32_16x16x32_bf16 v[28:31], a[124:127], v[152:155], v[28:31]
    v_mfma_f32_16x16x32_bf16 v[28:31], a[128:131], v[156:159], v[28:31]
    ds_read_b64_tr_b16 a[134:135], v8 offset:1536
    v_mfma_f32_16x16x32_bf16 v[44:47], a[128:131], v[160:163], v[44:47]
    ds_read_b64_tr_b16 a[132:133], v8 offset:1024
    v_mfma_f32_16x16x32_bf16 v[44:47], a[124:127], v[156:159], v[44:47]
    ds_read_b64_tr_b16 a[138:139], v8 offset:9728
    v_mfma_f32_16x16x32_bf16 v[44:47], a[120:123], v[152:155], v[44:47]
    ds_read_b64_tr_b16 a[136:137], v8 offset:9216
    v_mfma_f32_16x16x32_bf16 v[60:63], a[120:123], v[156:159], v[60:63]
    ds_read_b64_tr_b16 a[142:143], v8 offset:17920
    v_mfma_f32_16x16x32_bf16 v[60:63], a[124:127], v[160:163], v[60:63]
    buffer_load_dwordx4 v10, s[16:19], 0 offen offset:1024 lds
    v_mfma_f32_16x16x32_bf16 v[60:63], a[128:131], v[164:167], v[60:63]
    s_mov_b32 m0, s72
    ds_read_b64_tr_b16 a[140:141], v8 offset:17408
    v_mfma_f32_16x16x32_bf16 v[76:79], a[128:131], v[168:171], v[76:79]
    s_add_u32 s16, s69, s56
    s_addc_u32 s17, s29, 0
    ds_read_b128 v[220:223], v4 offset:32768
    v_mfma_f32_16x16x32_bf16 v[76:79], a[124:127], v[164:167], v[76:79]
    ds_read_b128 v[224:227], v17 offset:34816
    v_mfma_f32_16x16x32_bf16 v[76:79], a[120:123], v[160:163], v[76:79]
    ds_read_b128 v[216:219], v2 offset:35584
    v_mfma_f32_16x16x32_bf16 v[92:95], a[120:123], v[164:167], v[92:95]
    ds_read_b128 v[212:215], v2 offset:33536
    v_mfma_f32_16x16x32_bf16 v[92:95], a[124:127], v[168:171], v[92:95]
    ds_read_b128 v[208:211], v2 offset:35328
    v_mfma_f32_16x16x32_bf16 v[92:95], a[128:131], v[172:175], v[92:95]
    ds_read_b128 v[204:207], v2 offset:33280
    v_mfma_f32_16x16x32_bf16 v[108:111], a[128:131], v[176:179], v[108:111]
    ds_read_b128 v[200:203], v2 offset:35072
    v_mfma_f32_16x16x32_bf16 v[108:111], a[124:127], v[172:175], v[108:111]
    buffer_load_dwordx4 v10, s[16:19], 0 offen offset:0 lds
    v_mfma_f32_16x16x32_bf16 v[108:111], a[120:123], v[168:171], v[108:111]
    ds_read_b128 v[196:199], v2 offset:33024
    v_mfma_f32_16x16x32_bf16 v[124:127], a[120:123], v[172:175], v[124:127]
    ds_read_b128 v[192:195], v2 offset:34816
    v_mfma_f32_16x16x32_bf16 v[124:127], a[124:127], v[176:179], v[124:127]
    ds_read_b128 v[188:191], v2 offset:32768
    v_mfma_f32_16x16x32_bf16 v[124:127], a[128:131], v[180:183], v[124:127]
    v_mfma_f32_16x16x32_bf16 v[140:143], a[128:131], v[184:187], v[140:143]
    v_mfma_f32_16x16x32_bf16 v[140:143], a[124:127], v[180:183], v[140:143]
    v_mfma_f32_16x16x32_bf16 v[140:143], a[120:123], v[176:179], v[140:143]
    s_waitcnt lgkmcnt(3)
    v_mfma_f32_16x16x32_bf16 v[144:147], a[132:135], v[176:179], v[144:147]
    v_mfma_f32_16x16x32_bf16 v[144:147], a[136:139], v[180:183], v[144:147]
    buffer_load_dwordx4 v10, s[16:19], 0 offen offset:1024 lds
    v_mfma_f32_16x16x32_bf16 v[144:147], a[140:143], v[184:187], v[144:147]
    s_mov_b32 m0, s73
    s_add_u32 s16, s70, s56
    s_addc_u32 s17, s31, 0
    v_mfma_f32_16x16x32_bf16 v[128:131], a[140:143], v[180:183], v[128:131]
    v_mfma_f32_16x16x32_bf16 v[128:131], a[136:139], v[176:179], v[128:131]
    s_waitcnt vmcnt(12) lgkmcnt(0)
    s_barrier
    v_mfma_f32_16x16x32_bf16 v[128:131], a[132:135], v[172:175], v[128:131]
    v_mfma_f32_16x16x32_bf16 v[112:115], a[132:135], v[168:171], v[112:115]
    v_mfma_f32_16x16x32_bf16 v[112:115], a[136:139], v[172:175], v[112:115]
    v_mfma_f32_16x16x32_bf16 v[112:115], a[140:143], v[176:179], v[112:115]
    v_mfma_f32_16x16x32_bf16 v[96:99], a[140:143], v[172:175], v[96:99]
    v_mfma_f32_16x16x32_bf16 v[96:99], a[136:139], v[168:171], v[96:99]
    buffer_load_dwordx4 v10, s[16:19], 0 offen offset:0 lds
    v_mfma_f32_16x16x32_bf16 v[96:99], a[132:135], v[164:167], v[96:99]
    ds_read_b64_tr_b16 a[146:147], v6 offset:25088
    v_mfma_f32_16x16x32_bf16 v[80:83], a[132:135], v[160:163], v[80:83]
    ds_read_b64_tr_b16 a[144:145], v6 offset:24576
    v_mfma_f32_16x16x32_bf16 v[80:83], a[136:139], v[164:167], v[80:83]
    ds_read_b64_tr_b16 a[150:151], v6 offset:33280
    v_mfma_f32_16x16x32_bf16 v[80:83], a[140:143], v[168:171], v[80:83]
    ds_read_b64_tr_b16 a[148:149], v6 offset:32768
    v_mfma_f32_16x16x32_bf16 v[64:67], a[140:143], v[164:167], v[64:67]
    ds_read_b64_tr_b16 a[154:155], v6 offset:41472
    v_mfma_f32_16x16x32_bf16 v[64:67], a[136:139], v[160:163], v[64:67]
    ds_read_b64_tr_b16 a[152:153], v6 offset:40960
    v_mfma_f32_16x16x32_bf16 v[64:67], a[132:135], v[156:159], v[64:67]
    v_mfma_f32_16x16x32_bf16 v[48:51], a[132:135], v[152:155], v[48:51]
    v_mfma_f32_16x16x32_bf16 v[48:51], a[136:139], v[156:159], v[48:51]
    buffer_load_dwordx4 v10, s[16:19], 0 offen offset:1024 lds
    v_mfma_f32_16x16x32_bf16 v[48:51], a[140:143], v[160:163], v[48:51]
    s_add_u32 m0, s71, s5
    s_add_u32 s16, s68, s57
    s_addc_u32 s17, s28, 0
    v_mfma_f32_16x16x32_bf16 v[32:35], a[140:143], v[156:159], v[32:35]
    v_mfma_f32_16x16x32_bf16 v[32:35], a[136:139], v[152:155], v[32:35]
    v_mfma_f32_16x16x32_bf16 v[32:35], a[132:135], v[148:151], v[32:35]
    s_waitcnt lgkmcnt(0)
    v_mfma_f32_16x16x32_bf16 v[20:23], a[144:147], v[188:191], v[20:23]
    v_mfma_f32_16x16x32_bf16 v[20:23], a[148:151], v[192:195], v[20:23]
    v_mfma_f32_16x16x32_bf16 v[20:23], a[152:155], v[196:199], v[20:23]
    v_mfma_f32_16x16x32_bf16 v[36:39], a[152:155], v[200:203], v[36:39]
    v_mfma_f32_16x16x32_bf16 v[36:39], a[148:151], v[196:199], v[36:39]
    buffer_load_dwordx4 v10, s[16:19], 0 offen offset:0 lds
    v_mfma_f32_16x16x32_bf16 v[36:39], a[144:147], v[192:195], v[36:39]
    v_mfma_f32_16x16x32_bf16 v[52:55], a[144:147], v[196:199], v[52:55]
    v_mfma_f32_16x16x32_bf16 v[52:55], a[148:151], v[200:203], v[52:55]
    v_mfma_f32_16x16x32_bf16 v[52:55], a[152:155], v[204:207], v[52:55]
    v_mfma_f32_16x16x32_bf16 v[68:71], a[152:155], v[208:211], v[68:71]
    v_mfma_f32_16x16x32_bf16 v[68:71], a[148:151], v[204:207], v[68:71]
    ds_read_b64_tr_b16 a[158:159], v8 offset:25088
    v_mfma_f32_16x16x32_bf16 v[68:71], a[144:147], v[200:203], v[68:71]
    ds_read_b64_tr_b16 a[156:157], v8 offset:24576
    v_mfma_f32_16x16x32_bf16 v[84:87], a[144:147], v[204:207], v[84:87]
    ds_read_b64_tr_b16 a[162:163], v8 offset:33280
    v_mfma_f32_16x16x32_bf16 v[84:87], a[148:151], v[208:211], v[84:87]
L_pg0:
    s_cmp_eq_u32 s30, 1
    s_cbranch_scc1 L_pg4
    buffer_load_dwordx4 v10, s[16:19], 0 offen offset:1024 lds
    v_mfma_f32_16x16x32_bf16 v[84:87], a[152:155], v[212:215], v[84:87]
    s_add_u32 m0, s71, s6
    ds_read_b64_tr_b16 a[160:161], v8 offset:32768
    v_mfma_f32_16x16x32_bf16 v[100:103], a[152:155], v[216:219], v[100:103]
    s_add_u32 s16, s68, s58
    s_addc_u32 s17, s28, 0
    ds_read_b64_tr_b16 a[166:167], v8 offset:41472
    v_mfma_f32_16x16x32_bf16 v[100:103], a[148:151], v[212:215], v[100:103]
    ds_read_b64_tr_b16 a[164:165], v8 offset:40960
    v_mfma_f32_16x16x32_bf16 v[100:103], a[144:147], v[208:211], v[100:103]
    v_mfma_f32_16x16x32_bf16 v[116:119], a[144:147], v[212:215], v[116:119]
    v_mfma_f32_16x16x32_bf16 v[116:119], a[148:151], v[216:219], v[116:119]
    v_mfma_f32_16x16x32_bf16 v[116:119], a[152:155], v[220:223], v[116:119]
    v_mfma_f32_16x16x32_bf16 v[132:135], a[152:155], v[224:227], v[132:135]
    v_mfma_f32_16x16x32_bf16 v[132:135], a[148:151], v[220:223], v[132:135]
    buffer_load_dwordx4 v10, s[16:19], 0 offen offset:0 lds
    v_mfma_f32_16x16x32_bf16 v[132:135], a[144:147], v[216:219], v[132:135]
    s_waitcnt lgkmcnt(0)
    v_mfma_f32_16x16x32_bf16 v[136:139], a[156:159], v[216:219], v[136:139]
    v_mfma_f32_16x16x32_bf16 v[136:139], a[160:163], v[220:223], v[136:139]
    v_mfma_f32_16x16x32_bf16 v[136:139], a[164:167], v[224:227], v[136:139]
    v_mfma_f32_16x16x32_bf16 v[120:123], a[164:167], v[220:223], v[120:123]
    v_mfma_f32_16x16x32_bf16 v[120:123], a[160:163], v[216:219], v[120:123]
    v_mfma_f32_16x16x32_bf16 v[120:123], a[156:159], v[212:215], v[120:123]
    buffer_load_dwordx4 v10, s[16:19], 0 offen offset:1024 lds
    v_mfma_f32_16x16x32_bf16 v[104:107], a[156:159], v[208:211], v[104:107]
    s_add_u32 m0, s72, s5
    s_add_u32 s16, s69, s57
    s_addc_u32 s17, s29, 0
    v_mfma_f32_16x16x32_bf16 v[104:107], a[160:163], v[212:215], v[104:107]
    v_mfma_f32_16x16x32_bf16 v[104:107], a[164:167], v[216:219], v[104:107]
    v_mfma_f32_16x16x32_bf16 v[88:91], a[164:167], v[212:215], v[88:91]
    v_mfma_f32_16x16x32_bf16 v[88:91], a[160:163], v[208:211], v[88:91]
    ds_read_b64_tr_b16 a[170:171], v6 offset:26112
    v_mfma_f32_16x16x32_bf16 v[88:91], a[156:159], v[204:207], v[88:91]
    ds_read_b64_tr_b16 a[168:169], v6 offset:25600
    v_mfma_f32_16x16x32_bf16 v[72:75], a[156:159], v[200:203], v[72:75]
    buffer_load_dwordx4 v10, s[16:19], 0 offen offset:0 lds
    v_mfma_f32_16x16x32_bf16 v[72:75], a[160:163], v[204:207], v[72:75]
    ds_read_b64_tr_b16 a[174:175], v6 offset:34304
    v_mfma_f32_16x16x32_bf16 v[72:75], a[164:167], v[208:211], v[72:75]
    ds_read_b64_tr_b16 a[172:173], v6 offset:33792
    v_mfma_f32_16x16x32_bf16 v[56:59], a[164:167], v[204:207], v[56:59]
    ds_read_b64_tr_b16 a[178:179], v6 offset:42496
    v_mfma_f32_16x16x32_bf16 v[56:59], a[160:163], v[200:203], v[56:59]
    ds_read_b64_tr_b16 a[176:177], v6 offset:41984
    v_mfma_f32_16x16x32_bf16 v[56:59], a[156:159], v[196:199], v[56:59]
    v_mfma_f32_16x16x32_bf16 v[40:43], a[156:159], v[192:195], v[40:43]
    v_mfma_f32_16x16x32_bf16 v[40:43], a[160:163], v[196:199], v[40:43]
    buffer_load_dwordx4 v10, s[16:19], 0 offen offset:1024 lds
    v_mfma_f32_16x16x32_bf16 v[40:43], a[164:167], v[200:203], v[40:43]
    s_add_u32 m0, s72, s6
    s_add_u32 s16, s69, s58
    s_addc_u32 s17, s29, 0
    v_mfma_f32_16x16x32_bf16 v[24:27], a[164:167], v[196:199], v[24:27]
    v_mfma_f32_16x16x32_bf16 v[24:27], a[160:163], v[192:195], v[24:27]
    v_mfma_f32_16x16x32_bf16 v[24:27], a[156:159], v[188:191], v[24:27]
    s_waitcnt lgkmcnt(0)
    v_mfma_f32_16x16x32_bf16 v[28:31], a[168:171], v[188:191], v[28:31]
    v_mfma_f32_16x16x32_bf16 v[28:31], a[172:175], v[192:195], v[28:31]
    v_mfma_f32_16x16x32_bf16 v[28:31], a[176:179], v[196:199], v[28:31]
    buffer_load_dwordx4 v10, s[16:19], 0 offen offset:0 lds
    v_mfma_f32_16x16x32_bf16 v[44:47], a[176:179], v[200:203], v[44:47]
    v_mfma_f32_16x16x32_bf16 v[44:47], a[172:175], v[196:199], v[44:47]
    v_mfma_f32_16x16x32_bf16 v[44:47], a[168:171], v[192:195], v[44:47]
    v_mfma_f32_16x16x32_bf16 v[60:63], a[168:171], v[196:199], v[60:63]
    v_mfma_f32_16x16x32_bf16 v[60:63], a[172:175], v[200:203], v[60:63]
    v_mfma_f32_16x16x32_bf16 v[60:63], a[176:179], v[204:207], v[60:63]
    v_mfma_f32_16x16x32_bf16 v[76:79], a[176:179], v[208:211], v[76:79]
    buffer_load_dwordx4 v10, s[16:19], 0 offen offset:1024 lds
    v_mfma_f32_16x16x32_bf16 v[76:79], a[172:175], v[204:207], v[76:79]
    s_add_u32 m0, s73, s5
    ds_read_b64_tr_b16 a[182:183], v8 offset:26112
    v_mfma_f32_16x16x32_bf16 v[76:79], a[168:171], v[200:203], v[76:79]
    s_add_u32 s16, s70, s57
    s_addc_u32 s17, s31, 0
    ds_read_b64_tr_b16 a[180:181], v8 offset:25600
    v_mfma_f32_16x16x32_bf16 v[92:95], a[168:171], v[204:207], v[92:95]
    ds_read_b64_tr_b16 a[186:187], v8 offset:34304
    v_mfma_f32_16x16x32_bf16 v[92:95], a[172:175], v[208:211], v[92:95]
    ds_read_b64_tr_b16 a[184:185], v8 offset:33792
    v_mfma_f32_16x16x32_bf16 v[92:95], a[176:179], v[212:215], v[92:95]
    ds_read_b64_tr_b16 a[190:191], v8 offset:42496
    v_mfma_f32_16x16x32_bf16 v[108:111], a[176:179], v[216:219], v[108:111]
    ds_read_b64_tr_b16 a[188:189], v8 offset:41984
    v_mfma_f32_16x16x32_bf16 v[108:111], a[172:175], v[212:215], v[108:111]
    buffer_load_dwordx4 v10, s[16:19], 0 offen offset:0 lds
    v_mfma_f32_16x16x32_bf16 v[108:111], a[168:171], v[208:211], v[108:111]
    v_mfma_f32_16x16x32_bf16 v[124:127], a[168:171], v[212:215], v[124:127]
    v_mfma_f32_16x16x32_bf16 v[124:127], a[172:175], v[216:219], v[124:127]
    v_mfma_f32_16x16x32_bf16 v[124:127], a[176:179], v[220:223], v[124:127]
    v_mfma_f32_16x16x32_bf16 v[140:143], a[176:179], v[224:227], v[140:143]
    v_mfma_f32_16x16x32_bf16 v[140:143], a[172:175], v[220:223], v[140:143]
    v_mfma_f32_16x16x32_bf16 v[140:143], a[168:171], v[216:219], v[140:143]
    s_waitcnt lgkmcnt(0)
    buffer_load_dwordx4 v10, s[16:19], 0 offen offset:1024 lds
    v_mfma_f32_16x16x32_bf16 v[144:147], a[180:183], v[216:219], v[144:147]
    s_add_u32 m0, s73, s6
    s_add_u32 s16, s70, s58
    s_addc_u32 s17, s31, 0
    v_mfma_f32_16x16x32_bf16 v[144:147], a[184:187], v[220:223], v[144:147]
    v_mfma_f32_16x16x32_bf16 v[144:147], a[188:191], v[224:227], v[144:147]
    v_mfma_f32_16x16x32_bf16 v[128:131], a[188:191], v[220:223], v[128:131]
    v_mfma_f32_16x16x32_bf16 v[128:131], a[184:187], v[216:219], v[128:131]
    s_waitcnt vmcnt(10)
    s_barrier
    v_mfma_f32_16x16x32_bf16 v[128:131], a[180:183], v[212:215], v[128:131]
    v_mfma_f32_16x16x32_bf16 v[112:115], a[180:183], v[208:211], v[112:115]
    buffer_load_dwordx4 v10, s[16:19], 0 offen offset:0 lds
    v_mfma_f32_16x16x32_bf16 v[112:115], a[184:187], v[212:215], v[112:115]
    ds_read_b64_tr_b16 a[194:195], v5 offset:512
    v_mfma_f32_16x16x32_bf16 v[112:115], a[188:191], v[216:219], v[112:115]
    ds_read_b64_tr_b16 a[192:193], v5 offset:0
    v_mfma_f32_16x16x32_bf16 v[96:99], a[188:191], v[212:215], v[96:99]
    ds_read_b128 v[148:151], v1 offset:0
    v_mfma_f32_16x16x32_bf16 v[96:99], a[184:187], v[208:211], v[96:99]
    ds_read_b64_tr_b16 a[198:199], v5 offset:8704
    v_mfma_f32_16x16x32_bf16 v[96:99], a[180:183], v[204:207], v[96:99]
    ds_read_b64_tr_b16 a[196:197], v5 offset:8192
    v_mfma_f32_16x16x32_bf16 v[80:83], a[180:183], v[200:203], v[80:83]
    ds_read_b128 v[152:155], v1 offset:2048
    v_mfma_f32_16x16x32_bf16 v[80:83], a[184:187], v[204:207], v[80:83]
    buffer_load_dwordx4 v10, s[16:19], 0 offen offset:1024 lds
    v_mfma_f32_16x16x32_bf16 v[80:83], a[188:191], v[208:211], v[80:83]
    s_add_u32 m0, s74, s4
    ds_read_b64_tr_b16 a[202:203], v5 offset:16896
    s_lshr_b32 s32, s58, 10
    v_mfma_f32_16x16x32_bf16 v[64:67], a[188:191], v[204:207], v[64:67]
    s_add_u32 s12, s42, s32
    s_addc_u32 s13, s43, 0
    ds_read_b64_tr_b16 a[200:201], v5 offset:16384
    v_mfma_f32_16x16x32_bf16 v[64:67], a[184:187], v[200:203], v[64:67]
    ds_read_b128 v[156:159], v1 offset:256
    v_mfma_f32_16x16x32_bf16 v[64:67], a[180:183], v[196:199], v[64:67]
    ds_read_b128 v[160:163], v1 offset:2304
    v_mfma_f32_16x16x32_bf16 v[48:51], a[180:183], v[192:195], v[48:51]
    v_mfma_f32_16x16x32_bf16 v[48:51], a[184:187], v[196:199], v[48:51]
    v_mfma_f32_16x16x32_bf16 v[48:51], a[188:191], v[200:203], v[48:51]
    buffer_load_dwordx4 v252, s[12:15], 0 offen offset:0 lds
    v_mfma_f32_16x16x32_bf16 v[32:35], a[188:191], v[196:199], v[32:35]
    v_mfma_f32_16x16x32_bf16 v[32:35], a[184:187], v[192:195], v[32:35]
    ds_read_b128 v[164:167], v1 offset:512
    v_mfma_f32_16x16x32_bf16 v[32:35], a[180:183], v[188:191], v[32:35]
    s_waitcnt lgkmcnt(2)
    ds_read_b128 v[168:171], v1 offset:2560
    v_mfma_f32_16x16x32_bf16 v[20:23], a[192:195], v[148:151], v[20:23]
    v_mfma_f32_16x16x32_bf16 v[20:23], a[196:199], v[152:155], v[20:23]
    v_mfma_f32_16x16x32_bf16 v[20:23], a[200:203], v[156:159], v[20:23]
    s_waitcnt lgkmcnt(2)
    v_mfma_f32_16x16x32_bf16 v[36:39], a[200:203], v[160:163], v[36:39]
    buffer_load_dwordx4 v252, s[12:15], 0 offen offset:1024 lds
    v_mfma_f32_16x16x32_bf16 v[36:39], a[196:199], v[156:159], v[36:39]
    s_add_u32 m0, s75, s4
    ds_read_b128 v[172:175], v1 offset:768
    v_mfma_f32_16x16x32_bf16 v[36:39], a[192:195], v[152:155], v[36:39]
    ds_read_b128 v[176:179], v1 offset:2816
    v_mfma_f32_16x16x32_bf16 v[52:55], a[192:195], v[156:159], v[52:55]
    v_mfma_f32_16x16x32_bf16 v[52:55], a[196:199], v[160:163], v[52:55]
    s_waitcnt lgkmcnt(2)
    v_mfma_f32_16x16x32_bf16 v[52:55], a[200:203], v[164:167], v[52:55]
    ds_read_b128 v[180:183], v3 offset:0
    v_mfma_f32_16x16x32_bf16 v[68:71], a[200:203], v[168:171], v[68:71]
    ds_read_b128 v[184:187], v16 offset:2048
    v_mfma_f32_16x16x32_bf16 v[68:71], a[196:199], v[164:167], v[68:71]
    buffer_load_dwordx4 v253, s[12:15], 0 offen offset:0 lds
    v_mfma_f32_16x16x32_bf16 v[68:71], a[192:195], v[160:163], v[68:71]
    ds_read_b64_tr_b16 a[206:207], v7 offset:512
    v_mfma_f32_16x16x32_bf16 v[84:87], a[192:195], v[164:167], v[84:87]
    ds_read_b64_tr_b16 a[204:205], v7 offset:0
    v_mfma_f32_16x16x32_bf16 v[84:87], a[196:199], v[168:171], v[84:87]
    s_waitcnt lgkmcnt(4)
    ds_read_b64_tr_b16 a[210:211], v7 offset:8704
    v_mfma_f32_16x16x32_bf16 v[84:87], a[200:203], v[172:175], v[84:87]
    ds_read_b64_tr_b16 a[208:209], v7 offset:8192
    v_mfma_f32_16x16x32_bf16 v[100:103], a[200:203], v[176:179], v[100:103]
    ds_read_b64_tr_b16 a[214:215], v7 offset:16896
    v_mfma_f32_16x16x32_bf16 v[100:103], a[196:199], v[172:175], v[100:103]
    ds_read_b64_tr_b16 a[212:213], v7 offset:16384
    v_mfma_f32_16x16x32_bf16 v[100:103], a[192:195], v[168:171], v[100:103]
    buffer_load_dwordx4 v253, s[12:15], 0 offen offset:1024 lds
    v_mfma_f32_16x16x32_bf16 v[116:119], a[192:195], v[172:175], v[116:119]
    s_add_u32 m0, s76, s4
    v_mfma_f32_16x16x32_bf16 v[116:119], a[196:199], v[176:179], v[116:119]
    s_waitcnt lgkmcnt(4)
    v_mfma_f32_16x16x32_bf16 v[116:119], a[200:203], v[180:183], v[116:119]
    v_mfma_f32_16x16x32_bf16 v[132:135], a[200:203], v[184:187], v[132:135]
    v_mfma_f32_16x16x32_bf16 v[132:135], a[196:199], v[180:183], v[132:135]
    v_mfma_f32_16x16x32_bf16 v[132:135], a[192:195], v[176:179], v[132:135]
    v_mfma_f32_16x16x32_bf16 v[136:139], a[204:207], v[176:179], v[136:139]
    s_waitcnt lgkmcnt(0)
    buffer_load_dwordx4 v254, s[12:15], 0 offen offset:0 lds
    v_mfma_f32_16x16x32_bf16 v[136:139], a[208:211], v[180:183], v[136:139]
    v_mfma_f32_16x16x32_bf16 v[136:139], a[212:215], v[184:187], v[136:139]
    v_mfma_f32_16x16x32_bf16 v[120:123], a[212:215], v[180:183], v[120:123]
    v_mfma_f32_16x16x32_bf16 v[120:123], a[208:211], v[176:179], v[120:123]
    v_mfma_f32_16x16x32_bf16 v[120:123], a[204:207], v[172:175], v[120:123]
    v_mfma_f32_16x16x32_bf16 v[104:107], a[204:207], v[168:171], v[104:107]
    v_mfma_f32_16x16x32_bf16 v[104:107], a[208:211], v[172:175], v[104:107]
    buffer_load_dwordx4 v254, s[12:15], 0 offen offset:1024 lds
    v_mfma_f32_16x16x32_bf16 v[104:107], a[212:215], v[176:179], v[104:107]
    s_add_u32 m0, s77, s4
    v_mfma_f32_16x16x32_bf16 v[88:91], a[212:215], v[172:175], v[88:91]
    v_mfma_f32_16x16x32_bf16 v[88:91], a[208:211], v[168:171], v[88:91]
    ds_read_b64_tr_b16 a[218:219], v5 offset:1536
    v_mfma_f32_16x16x32_bf16 v[88:91], a[204:207], v[164:167], v[88:91]
    ds_read_b64_tr_b16 a[216:217], v5 offset:1024
    v_mfma_f32_16x16x32_bf16 v[72:75], a[204:207], v[160:163], v[72:75]
    ds_read_b64_tr_b16 a[222:223], v5 offset:9728
    v_mfma_f32_16x16x32_bf16 v[72:75], a[208:211], v[164:167], v[72:75]
    ds_read_b64_tr_b16 a[220:221], v5 offset:9216
    v_mfma_f32_16x16x32_bf16 v[72:75], a[212:215], v[168:171], v[72:75]
    buffer_load_dwordx4 v255, s[12:15], 0 offen offset:0 lds
    v_mfma_f32_16x16x32_bf16 v[56:59], a[212:215], v[164:167], v[56:59]
    ds_read_b64_tr_b16 a[226:227], v5 offset:17920
    v_mfma_f32_16x16x32_bf16 v[56:59], a[208:211], v[160:163], v[56:59]
    ds_read_b64_tr_b16 a[224:225], v5 offset:17408
    v_mfma_f32_16x16x32_bf16 v[56:59], a[204:207], v[156:159], v[56:59]
    v_mfma_f32_16x16x32_bf16 v[40:43], a[204:207], v[152:155], v[40:43]
    v_mfma_f32_16x16x32_bf16 v[40:43], a[208:211], v[156:159], v[40:43]
    v_mfma_f32_16x16x32_bf16 v[40:43], a[212:215], v[160:163], v[40:43]
    ds_read_b64_tr_b16 a[230:231], v7 offset:1536
    v_mfma_f32_16x16x32_bf16 v[24:27], a[212:215], v[156:159], v[24:27]
    buffer_load_dwordx4 v255, s[12:15], 0 offen offset:1024 lds
    v_mfma_f32_16x16x32_bf16 v[24:27], a[208:211], v[152:155], v[24:27]
    s_add_u32 m0, s71, s7
    ds_read_b64_tr_b16 a[228:229], v7 offset:1024
    v_mfma_f32_16x16x32_bf16 v[24:27], a[204:207], v[148:151], v[24:27]
    s_waitcnt lgkmcnt(2)
    ds_read_b64_tr_b16 a[234:235], v7 offset:9728
    v_mfma_f32_16x16x32_bf16 v[28:31], a[216:219], v[148:151], v[28:31]
    s_add_u32 s16, s68, s59
    s_addc_u32 s17, s28, 0
    ds_read_b64_tr_b16 a[232:233], v7 offset:9216
    v_mfma_f32_16x16x32_bf16 v[28:31], a[220:223], v[152:155], v[28:31]
    ds_read_b64_tr_b16 a[238:239], v7 offset:17920
    v_mfma_f32_16x16x32_bf16 v[28:31], a[224:227], v[156:159], v[28:31]
    ds_read_b64_tr_b16 a[236:237], v7 offset:17408
    v_mfma_f32_16x16x32_bf16 v[44:47], a[224:227], v[160:163], v[44:47]
    ds_read_b128 v[220:223], v4 offset:0
    v_mfma_f32_16x16x32_bf16 v[44:47], a[220:223], v[156:159], v[44:47]
    buffer_load_dwordx4 v10, s[16:19], 0 offen offset:0 lds
    v_mfma_f32_16x16x32_bf16 v[44:47], a[216:219], v[152:155], v[44:47]
    ds_read_b128 v[224:227], v17 offset:2048
    v_mfma_f32_16x16x32_bf16 v[60:63], a[216:219], v[156:159], v[60:63]
    ds_read_b128 v[216:219], v2 offset:2816
    v_mfma_f32_16x16x32_bf16 v[60:63], a[220:223], v[160:163], v[60:63]
    ds_read_b128 v[212:215], v2 offset:768
    v_mfma_f32_16x16x32_bf16 v[60:63], a[224:227], v[164:167], v[60:63]
    ds_read_b128 v[208:211], v2 offset:2560
    v_mfma_f32_16x16x32_bf16 v[76:79], a[224:227], v[168:171], v[76:79]
    ds_read_b128 v[204:207], v2 offset:512
    v_mfma_f32_16x16x32_bf16 v[76:79], a[220:223], v[164:167], v[76:79]
    ds_read_b128 v[200:203], v2 offset:2304
    v_mfma_f32_16x16x32_bf16 v[76:79], a[216:219], v[160:163], v[76:79]
    buffer_load_dwordx4 v10, s[16:19], 0 offen offset:1024 lds
    v_mfma_f32_16x16x32_bf16 v[92:95], a[216:219], v[164:167], v[92:95]
    s_add_u32 m0, s72, s7
    ds_read_b128 v[196:199], v2 offset:256
    v_mfma_f32_16x16x32_bf16 v[92:95], a[220:223], v[168:171], v[92:95]
    s_add_u32 s16, s69, s59
    s_addc_u32 s17, s29, 0
    ds_read_b128 v[192:195], v2 offset:2048
    v_mfma_f32_16x16x32_bf16 v[92:95], a[224:227], v[172:175], v[92:95]
    ds_read_b128 v[188:191], v2 offset:0
    v_mfma_f32_16x16x32_bf16 v[108:111], a[224:227], v[176:179], v[108:111]
    v_mfma_f32_16x16x32_bf16 v[108:111], a[220:223], v[172:175], v[108:111]
    v_mfma_f32_16x16x32_bf16 v[108:111], a[216:219], v[168:171], v[108:111]
    v_mfma_f32_16x16x32_bf16 v[124:127], a[216:219], v[172:175], v[124:127]
    buffer_load_dwordx4 v10, s[16:19], 0 offen offset:0 lds
    v_mfma_f32_16x16x32_bf16 v[124:127], a[220:223], v[176:179], v[124:127]
    v_mfma_f32_16x16x32_bf16 v[124:127], a[224:227], v[180:183], v[124:127]
    v_mfma_f32_16x16x32_bf16 v[140:143], a[224:227], v[184:187], v[140:143]
    v_mfma_f32_16x16x32_bf16 v[140:143], a[220:223], v[180:183], v[140:143]
    v_mfma_f32_16x16x32_bf16 v[140:143], a[216:219], v[176:179], v[140:143]
    s_waitcnt vmcnt(11) lgkmcnt(0)
    s_barrier
    v_mfma_f32_16x16x32_bf16 v[144:147], a[228:231], v[176:179], v[144:147]
    v_mfma_f32_16x16x32_bf16 v[144:147], a[232:235], v[180:183], v[144:147]
    buffer_load_dwordx4 v10, s[16:19], 0 offen offset:1024 lds
    v_mfma_f32_16x16x32_bf16 v[144:147], a[236:239], v[184:187], v[144:147]
    s_add_u32 m0, s73, s7
    s_add_u32 s16, s70, s59
    s_addc_u32 s17, s31, 0
    v_mfma_f32_16x16x32_bf16 v[128:131], a[236:239], v[180:183], v[128:131]
    v_mfma_f32_16x16x32_bf16 v[128:131], a[232:235], v[176:179], v[128:131]
    v_mfma_f32_16x16x32_bf16 v[128:131], a[228:231], v[172:175], v[128:131]
    v_mfma_f32_16x16x32_bf16 v[112:115], a[228:231], v[168:171], v[112:115]
    v_mfma_f32_16x16x32_bf16 v[112:115], a[232:235], v[172:175], v[112:115]
    v_mfma_f32_16x16x32_bf16 v[112:115], a[236:239], v[176:179], v[112:115]
    buffer_load_dwordx4 v10, s[16:19], 0 offen offset:0 lds
    v_mfma_f32_16x16x32_bf16 v[96:99], a[236:239], v[172:175], v[96:99]
    v_mfma_f32_16x16x32_bf16 v[96:99], a[232:235], v[168:171], v[96:99]
    ds_read_b64_tr_b16 a[2:3], v5 offset:25088
    v_mfma_f32_16x16x32_bf16 v[96:99], a[228:231], v[164:167], v[96:99]
    ds_read_b64_tr_b16 a[0:1], v5 offset:24576
    v_mfma_f32_16x16x32_bf16 v[80:83], a[228:231], v[160:163], v[80:83]
    ds_read_b64_tr_b16 a[6:7], v5 offset:33280
    v_mfma_f32_16x16x32_bf16 v[80:83], a[232:235], v[164:167], v[80:83]
    ds_read_b64_tr_b16 a[4:5], v5 offset:32768
    v_mfma_f32_16x16x32_bf16 v[80:83], a[236:239], v[168:171], v[80:83]
    ds_read_b64_tr_b16 a[10:11], v5 offset:41472
    v_mfma_f32_16x16x32_bf16 v[64:67], a[236:239], v[164:167], v[64:67]
    buffer_load_dwordx4 v10, s[16:19], 0 offen offset:1024 lds
    v_mfma_f32_16x16x32_bf16 v[64:67], a[232:235], v[160:163], v[64:67]
    s_mov_b32 m0, s71
    ds_read_b64_tr_b16 a[8:9], v5 offset:40960
    v_mfma_f32_16x16x32_bf16 v[64:67], a[228:231], v[156:159], v[64:67]
    s_add_u32 s16, s68, s60
    s_addc_u32 s17, s28, 0
    v_mfma_f32_16x16x32_bf16 v[48:51], a[228:231], v[152:155], v[48:51]
    v_mfma_f32_16x16x32_bf16 v[48:51], a[232:235], v[156:159], v[48:51]
    v_mfma_f32_16x16x32_bf16 v[48:51], a[236:239], v[160:163], v[48:51]
    v_mfma_f32_16x16x32_bf16 v[32:35], a[236:239], v[156:159], v[32:35]
    v_mfma_f32_16x16x32_bf16 v[32:35], a[232:235], v[152:155], v[32:35]
    buffer_load_dwordx4 v10, s[16:19], 0 offen offset:0 lds
    v_mfma_f32_16x16x32_bf16 v[32:35], a[228:231], v[148:151], v[32:35]
    s_waitcnt lgkmcnt(0)
    v_mfma_f32_16x16x32_bf16 v[20:23], a[0:3], v[188:191], v[20:23]
    v_mfma_f32_16x16x32_bf16 v[20:23], a[4:7], v[192:195], v[20:23]
    v_mfma_f32_16x16x32_bf16 v[20:23], a[8:11], v[196:199], v[20:23]
    v_mfma_f32_16x16x32_bf16 v[36:39], a[8:11], v[200:203], v[36:39]
    v_mfma_f32_16x16x32_bf16 v[36:39], a[4:7], v[196:199], v[36:39]
    v_mfma_f32_16x16x32_bf16 v[36:39], a[0:3], v[192:195], v[36:39]
    buffer_load_dwordx4 v10, s[16:19], 0 offen offset:1024 lds
    v_mfma_f32_16x16x32_bf16 v[52:55], a[0:3], v[196:199], v[52:55]
    s_mov_b32 m0, s72
    s_add_u32 s16, s69, s60
    s_addc_u32 s17, s29, 0
    v_mfma_f32_16x16x32_bf16 v[52:55], a[4:7], v[200:203], v[52:55]
    v_mfma_f32_16x16x32_bf16 v[52:55], a[8:11], v[204:207], v[52:55]
    v_mfma_f32_16x16x32_bf16 v[68:71], a[8:11], v[208:211], v[68:71]
    v_mfma_f32_16x16x32_bf16 v[68:71], a[4:7], v[204:207], v[68:71]
    ds_read_b64_tr_b16 a[14:15], v7 offset:25088
    v_mfma_f32_16x16x32_bf16 v[68:71], a[0:3], v[200:203], v[68:71]
    ds_read_b64_tr_b16 a[12:13], v7 offset:24576
    v_mfma_f32_16x16x32_bf16 v[84:87], a[0:3], v[204:207], v[84:87]
    buffer_load_dwordx4 v10, s[16:19], 0 offen offset:0 lds
    v_mfma_f32_16x16x32_bf16 v[84:87], a[4:7], v[208:211], v[84:87]
    ds_read_b64_tr_b16 a[18:19], v7 offset:33280
    v_mfma_f32_16x16x32_bf16 v[84:87], a[8:11], v[212:215], v[84:87]
    ds_read_b64_tr_b16 a[16:17], v7 offset:32768
    v_mfma_f32_16x16x32_bf16 v[100:103], a[8:11], v[216:219], v[100:103]
    ds_read_b64_tr_b16 a[22:23], v7 offset:41472
    v_mfma_f32_16x16x32_bf16 v[100:103], a[4:7], v[212:215], v[100:103]
    ds_read_b64_tr_b16 a[20:21], v7 offset:40960
    v_mfma_f32_16x16x32_bf16 v[100:103], a[0:3], v[208:211], v[100:103]
    v_mfma_f32_16x16x32_bf16 v[116:119], a[0:3], v[212:215], v[116:119]
    v_mfma_f32_16x16x32_bf16 v[116:119], a[4:7], v[216:219], v[116:119]
    buffer_load_dwordx4 v10, s[16:19], 0 offen offset:1024 lds
    v_mfma_f32_16x16x32_bf16 v[116:119], a[8:11], v[220:223], v[116:119]
    s_mov_b32 m0, s73
    s_add_u32 s16, s70, s60
    s_addc_u32 s17, s31, 0
    v_mfma_f32_16x16x32_bf16 v[132:135], a[8:11], v[224:227], v[132:135]
    ds_read_b64_tr_b16 a[26:27], v5 offset:26112
    v_mfma_f32_16x16x32_bf16 v[132:135], a[4:7], v[220:223], v[132:135]
    ds_read_b64_tr_b16 a[24:25], v5 offset:25600
    v_mfma_f32_16x16x32_bf16 v[132:135], a[0:3], v[216:219], v[132:135]
    s_waitcnt lgkmcnt(2)
    ds_read_b64_tr_b16 a[30:31], v5 offset:34304
    v_mfma_f32_16x16x32_bf16 v[136:139], a[12:15], v[216:219], v[136:139]
    ds_read_b64_tr_b16 a[28:29], v5 offset:33792
    v_mfma_f32_16x16x32_bf16 v[136:139], a[16:19], v[220:223], v[136:139]
    ds_read_b64_tr_b16 a[34:35], v5 offset:42496
    v_mfma_f32_16x16x32_bf16 v[136:139], a[20:23], v[224:227], v[136:139]
    buffer_load_dwordx4 v10, s[16:19], 0 offen offset:0 lds
    v_mfma_f32_16x16x32_bf16 v[120:123], a[20:23], v[220:223], v[120:123]
    ds_read_b64_tr_b16 a[32:33], v5 offset:41984
    v_mfma_f32_16x16x32_bf16 v[120:123], a[16:19], v[216:219], v[120:123]
    ds_read_b64_tr_b16 a[38:39], v7 offset:26112
    v_mfma_f32_16x16x32_bf16 v[120:123], a[12:15], v[212:215], v[120:123]
    ds_read_b64_tr_b16 a[36:37], v7 offset:25600
    v_mfma_f32_16x16x32_bf16 v[104:107], a[12:15], v[208:211], v[104:107]
    ds_read_b64_tr_b16 a[42:43], v7 offset:34304
    v_mfma_f32_16x16x32_bf16 v[104:107], a[16:19], v[212:215], v[104:107]
    ds_read_b64_tr_b16 a[40:41], v7 offset:33792
    v_mfma_f32_16x16x32_bf16 v[104:107], a[20:23], v[216:219], v[104:107]
    ds_read_b64_tr_b16 a[46:47], v7 offset:42496
    v_mfma_f32_16x16x32_bf16 v[88:91], a[20:23], v[212:215], v[88:91]
    buffer_load_dwordx4 v10, s[16:19], 0 offen offset:1024 lds
    v_mfma_f32_16x16x32_bf16 v[88:91], a[16:19], v[208:211], v[88:91]
    s_mov_b32 m0, s74
    ds_read_b64_tr_b16 a[44:45], v7 offset:41984
    s_lshr_b32 s32, s60, 10
    v_mfma_f32_16x16x32_bf16 v[88:91], a[12:15], v[204:207], v[88:91]
    s_add_u32 s12, s42, s32
    s_addc_u32 s13, s43, 0
    ds_read_b64_tr_b16 a[50:51], v6 offset:512
    v_mfma_f32_16x16x32_bf16 v[72:75], a[12:15], v[200:203], v[72:75]
    ds_read_b64_tr_b16 a[48:49], v6 offset:0
    v_mfma_f32_16x16x32_bf16 v[72:75], a[16:19], v[204:207], v[72:75]
    ds_read_b64_tr_b16 a[54:55], v6 offset:8704
    v_mfma_f32_16x16x32_bf16 v[72:75], a[20:23], v[208:211], v[72:75]
    ds_read_b64_tr_b16 a[52:53], v6 offset:8192
    v_mfma_f32_16x16x32_bf16 v[56:59], a[20:23], v[204:207], v[56:59]
    ds_read_b64_tr_b16 a[58:59], v6 offset:16896
    v_mfma_f32_16x16x32_bf16 v[56:59], a[16:19], v[200:203], v[56:59]
    buffer_load_dwordx4 v252, s[12:15], 0 offen offset:0 lds
    v_mfma_f32_16x16x32_bf16 v[56:59], a[12:15], v[196:199], v[56:59]
    ds_read_b64_tr_b16 a[56:57], v6 offset:16384
    v_mfma_f32_16x16x32_bf16 v[40:43], a[12:15], v[192:195], v[40:43]
    ds_read_b64_tr_b16 a[62:63], v8 offset:512
    v_mfma_f32_16x16x32_bf16 v[40:43], a[16:19], v[196:199], v[40:43]
    ds_read_b64_tr_b16 a[60:61], v8 offset:0
    v_mfma_f32_16x16x32_bf16 v[40:43], a[20:23], v[200:203], v[40:43]
    ds_read_b64_tr_b16 a[66:67], v8 offset:8704
    v_mfma_f32_16x16x32_bf16 v[24:27], a[20:23], v[196:199], v[24:27]
    ds_read_b64_tr_b16 a[64:65], v8 offset:8192
    v_mfma_f32_16x16x32_bf16 v[24:27], a[16:19], v[192:195], v[24:27]
    ds_read_b64_tr_b16 a[70:71], v8 offset:16896
    v_mfma_f32_16x16x32_bf16 v[24:27], a[12:15], v[188:191], v[24:27]
    s_waitcnt lgkmcnt(6)
    buffer_load_dwordx4 v252, s[12:15], 0 offen offset:1024 lds
    v_mfma_f32_16x16x32_bf16 v[28:31], a[24:27], v[188:191], v[28:31]
    s_mov_b32 m0, s75
    ds_read_b64_tr_b16 a[68:69], v8 offset:16384
    v_mfma_f32_16x16x32_bf16 v[28:31], a[28:31], v[192:195], v[28:31]
    ds_read_b64_tr_b16 a[74:75], v6 offset:1536
    v_mfma_f32_16x16x32_bf16 v[28:31], a[32:35], v[196:199], v[28:31]
    ds_read_b64_tr_b16 a[72:73], v6 offset:1024
    v_mfma_f32_16x16x32_bf16 v[44:47], a[32:35], v[200:203], v[44:47]
    ds_read_b64_tr_b16 a[78:79], v6 offset:9728
    v_mfma_f32_16x16x32_bf16 v[44:47], a[28:31], v[196:199], v[44:47]
    ds_read_b64_tr_b16 a[76:77], v6 offset:9216
    v_mfma_f32_16x16x32_bf16 v[44:47], a[24:27], v[192:195], v[44:47]
    ds_read_b64_tr_b16 a[82:83], v6 offset:17920
    v_mfma_f32_16x16x32_bf16 v[60:63], a[24:27], v[196:199], v[60:63]
    buffer_load_dwordx4 v253, s[12:15], 0 offen offset:0 lds
    v_mfma_f32_16x16x32_bf16 v[60:63], a[28:31], v[200:203], v[60:63]
    ds_read_b64_tr_b16 a[80:81], v6 offset:17408
    v_mfma_f32_16x16x32_bf16 v[60:63], a[32:35], v[204:207], v[60:63]
    ds_read_b64_tr_b16 a[86:87], v8 offset:1536
    v_mfma_f32_16x16x32_bf16 v[76:79], a[32:35], v[208:211], v[76:79]
    ds_read_b64_tr_b16 a[84:85], v8 offset:1024
    v_mfma_f32_16x16x32_bf16 v[76:79], a[28:31], v[204:207], v[76:79]
    ds_read_b64_tr_b16 a[90:91], v8 offset:9728
    v_mfma_f32_16x16x32_bf16 v[76:79], a[24:27], v[200:203], v[76:79]
    ds_read_b64_tr_b16 a[88:89], v8 offset:9216
    v_mfma_f32_16x16x32_bf16 v[92:95], a[24:27], v[204:207], v[92:95]
    ds_read_b64_tr_b16 a[94:95], v8 offset:17920
    v_mfma_f32_16x16x32_bf16 v[92:95], a[28:31], v[208:211], v[92:95]
    buffer_load_dwordx4 v253, s[12:15], 0 offen offset:1024 lds
    v_mfma_f32_16x16x32_bf16 v[92:95], a[32:35], v[212:215], v[92:95]
    s_mov_b32 m0, s76
    ds_read_b64_tr_b16 a[92:93], v8 offset:17408
    v_mfma_f32_16x16x32_bf16 v[108:111], a[32:35], v[216:219], v[108:111]
    v_mfma_f32_16x16x32_bf16 v[108:111], a[28:31], v[212:215], v[108:111]
    v_mfma_f32_16x16x32_bf16 v[108:111], a[24:27], v[208:211], v[108:111]
    v_mfma_f32_16x16x32_bf16 v[124:127], a[24:27], v[212:215], v[124:127]
    v_mfma_f32_16x16x32_bf16 v[124:127], a[28:31], v[216:219], v[124:127]
    v_mfma_f32_16x16x32_bf16 v[124:127], a[32:35], v[220:223], v[124:127]
    buffer_load_dwordx4 v254, s[12:15], 0 offen offset:0 lds
    v_mfma_f32_16x16x32_bf16 v[140:143], a[32:35], v[224:227], v[140:143]
    v_mfma_f32_16x16x32_bf16 v[140:143], a[28:31], v[220:223], v[140:143]
    v_mfma_f32_16x16x32_bf16 v[140:143], a[24:27], v[216:219], v[140:143]
    s_waitcnt vmcnt(11) lgkmcnt(0)
    s_barrier
    v_mfma_f32_16x16x32_bf16 v[144:147], a[36:39], v[216:219], v[144:147]
    v_mfma_f32_16x16x32_bf16 v[144:147], a[40:43], v[220:223], v[144:147]
    v_mfma_f32_16x16x32_bf16 v[144:147], a[44:47], v[224:227], v[144:147]
    v_mfma_f32_16x16x32_bf16 v[128:131], a[44:47], v[220:223], v[128:131]
    buffer_load_dwordx4 v254, s[12:15], 0 offen offset:1024 lds
    v_mfma_f32_16x16x32_bf16 v[128:131], a[40:43], v[216:219], v[128:131]
    s_add_u32 m0, s71, s5
    s_add_u32 s16, s68, s61
    s_addc_u32 s17, s28, 0
    v_mfma_f32_16x16x32_bf16 v[128:131], a[36:39], v[212:215], v[128:131]
    v_mfma_f32_16x16x32_bf16 v[112:115], a[36:39], v[208:211], v[112:115]
    v_mfma_f32_16x16x32_bf16 v[112:115], a[40:43], v[212:215], v[112:115]
    v_mfma_f32_16x16x32_bf16 v[112:115], a[44:47], v[216:219], v[112:115]
    v_mfma_f32_16x16x32_bf16 v[96:99], a[44:47], v[212:215], v[96:99]
    v_mfma_f32_16x16x32_bf16 v[96:99], a[40:43], v[208:211], v[96:99]
    buffer_load_dwordx4 v10, s[16:19], 0 offen offset:0 lds
    v_mfma_f32_16x16x32_bf16 v[96:99], a[36:39], v[204:207], v[96:99]
    v_mfma_f32_16x16x32_bf16 v[80:83], a[36:39], v[200:203], v[80:83]
    v_mfma_f32_16x16x32_bf16 v[80:83], a[40:43], v[204:207], v[80:83]
    ds_read_b128 v[148:151], v1 offset:32768
    v_mfma_f32_16x16x32_bf16 v[80:83], a[44:47], v[208:211], v[80:83]
    ds_read_b128 v[152:155], v1 offset:34816
    v_mfma_f32_16x16x32_bf16 v[64:67], a[44:47], v[204:207], v[64:67]
    ds_read_b128 v[156:159], v1 offset:33024
    v_mfma_f32_16x16x32_bf16 v[64:67], a[40:43], v[200:203], v[64:67]
    ds_read_b128 v[160:163], v1 offset:35072
    v_mfma_f32_16x16x32_bf16 v[64:67], a[36:39], v[196:199], v[64:67]
    buffer_load_dwordx4 v10, s[16:19], 0 offen offset:1024 lds
    v_mfma_f32_16x16x32_bf16 v[48:51], a[36:39], v[192:195], v[48:51]
    s_add_u32 m0, s72, s5
    s_add_u32 s16, s69, s61
    s_addc_u32 s17, s29, 0
    v_mfma_f32_16x16x32_bf16 v[48:51], a[40:43], v[196:199], v[48:51]
    v_mfma_f32_16x16x32_bf16 v[48:51], a[44:47], v[200:203], v[48:51]
    v_mfma_f32_16x16x32_bf16 v[32:35], a[44:47], v[196:199], v[32:35]
    v_mfma_f32_16x16x32_bf16 v[32:35], a[40:43], v[192:195], v[32:35]
    ds_read_b128 v[164:167], v1 offset:33280
    v_mfma_f32_16x16x32_bf16 v[32:35], a[36:39], v[188:191], v[32:35]
    s_waitcnt lgkmcnt(1)
    ds_read_b128 v[168:171], v1 offset:35328
    v_mfma_f32_16x16x32_bf16 v[20:23], a[48:51], v[148:151], v[20:23]
    buffer_load_dwordx4 v10, s[16:19], 0 offen offset:0 lds
    v_mfma_f32_16x16x32_bf16 v[20:23], a[52:55], v[152:155], v[20:23]
    v_mfma_f32_16x16x32_bf16 v[20:23], a[56:59], v[156:159], v[20:23]
    v_mfma_f32_16x16x32_bf16 v[36:39], a[56:59], v[160:163], v[36:39]
    v_mfma_f32_16x16x32_bf16 v[36:39], a[52:55], v[156:159], v[36:39]
    ds_read_b128 v[172:175], v1 offset:33536
    v_mfma_f32_16x16x32_bf16 v[36:39], a[48:51], v[152:155], v[36:39]
    ds_read_b128 v[176:179], v1 offset:35584
    v_mfma_f32_16x16x32_bf16 v[52:55], a[48:51], v[156:159], v[52:55]
    v_mfma_f32_16x16x32_bf16 v[52:55], a[52:55], v[160:163], v[52:55]
    s_waitcnt lgkmcnt(2)
    buffer_load_dwordx4 v10, s[16:19], 0 offen offset:1024 lds
    v_mfma_f32_16x16x32_bf16 v[52:55], a[56:59], v[164:167], v[52:55]
    s_add_u32 m0, s73, s5
    s_add_u32 s16, s70, s61
    s_addc_u32 s17, s31, 0
    v_mfma_f32_16x16x32_bf16 v[68:71], a[56:59], v[168:171], v[68:71]
    v_mfma_f32_16x16x32_bf16 v[68:71], a[52:55], v[164:167], v[68:71]
    ds_read_b128 v[180:183], v3 offset:32768
    v_mfma_f32_16x16x32_bf16 v[68:71], a[48:51], v[160:163], v[68:71]
    ds_read_b128 v[184:187], v16 offset:34816
    v_mfma_f32_16x16x32_bf16 v[84:87], a[48:51], v[164:167], v[84:87]
    v_mfma_f32_16x16x32_bf16 v[84:87], a[52:55], v[168:171], v[84:87]
    s_waitcnt lgkmcnt(2)
    v_mfma_f32_16x16x32_bf16 v[84:87], a[56:59], v[172:175], v[84:87]
    buffer_load_dwordx4 v10, s[16:19], 0 offen offset:0 lds
    v_mfma_f32_16x16x32_bf16 v[100:103], a[56:59], v[176:179], v[100:103]
    v_mfma_f32_16x16x32_bf16 v[100:103], a[52:55], v[172:175], v[100:103]
    v_mfma_f32_16x16x32_bf16 v[100:103], a[48:51], v[168:171], v[100:103]
    v_mfma_f32_16x16x32_bf16 v[116:119], a[48:51], v[172:175], v[116:119]
    v_mfma_f32_16x16x32_bf16 v[116:119], a[52:55], v[176:179], v[116:119]
    s_waitcnt lgkmcnt(0)
    v_mfma_f32_16x16x32_bf16 v[116:119], a[56:59], v[180:183], v[116:119]
    v_mfma_f32_16x16x32_bf16 v[132:135], a[56:59], v[184:187], v[132:135]
    buffer_load_dwordx4 v10, s[16:19], 0 offen offset:1024 lds
    v_mfma_f32_16x16x32_bf16 v[132:135], a[52:55], v[180:183], v[132:135]
    s_mov_b32 m0, s77
    v_mfma_f32_16x16x32_bf16 v[132:135], a[48:51], v[176:179], v[132:135]
    v_mfma_f32_16x16x32_bf16 v[136:139], a[60:63], v[176:179], v[136:139]
    ds_read_b64_tr_b16 a[98:99], v6 offset:25088
    v_mfma_f32_16x16x32_bf16 v[136:139], a[64:67], v[180:183], v[136:139]
    ds_read_b64_tr_b16 a[96:97], v6 offset:24576
    v_mfma_f32_16x16x32_bf16 v[136:139], a[68:71], v[184:187], v[136:139]
    ds_read_b64_tr_b16 a[102:103], v6 offset:33280
    v_mfma_f32_16x16x32_bf16 v[120:123], a[68:71], v[180:183], v[120:123]
    ds_read_b64_tr_b16 a[100:101], v6 offset:32768
    v_mfma_f32_16x16x32_bf16 v[120:123], a[64:67], v[176:179], v[120:123]
    buffer_load_dwordx4 v255, s[12:15], 0 offen offset:0 lds
    v_mfma_f32_16x16x32_bf16 v[120:123], a[60:63], v[172:175], v[120:123]
    ds_read_b64_tr_b16 a[106:107], v6 offset:41472
    v_mfma_f32_16x16x32_bf16 v[104:107], a[60:63], v[168:171], v[104:107]
L_pg1:
    s_cmp_eq_u32 s30, 1
    s_cbranch_scc1 L_warm_ret
    ds_read_b64_tr_b16 a[104:105], v6 offset:40960
    v_mfma_f32_16x16x32_bf16 v[104:107], a[64:67], v[172:175], v[104:107]
    ds_read_b64_tr_b16 a[110:111], v8 offset:25088
    v_mfma_f32_16x16x32_bf16 v[104:107], a[68:71], v[176:179], v[104:107]
    ds_read_b64_tr_b16 a[108:109], v8 offset:24576
    v_mfma_f32_16x16x32_bf16 v[88:91], a[68:71], v[172:175], v[88:91]
    ds_read_b64_tr_b16 a[114:115], v8 offset:33280
    v_mfma_f32_16x16x32_bf16 v[88:91], a[64:67], v[168:171], v[88:91]
    ds_read_b64_tr_b16 a[112:113], v8 offset:32768
    v_mfma_f32_16x16x32_bf16 v[88:91], a[60:63], v[164:167], v[88:91]
    buffer_load_dwordx4 v255, s[12:15], 0 offen offset:1024 lds
    v_mfma_f32_16x16x32_bf16 v[72:75], a[60:63], v[160:163], v[72:75]
    s_add_u32 m0, s71, s6
    ds_read_b64_tr_b16 a[118:119], v8 offset:41472
    v_mfma_f32_16x16x32_bf16 v[72:75], a[64:67], v[164:167], v[72:75]
    s_add_u32 s16, s68, s62
    s_addc_u32 s17, s28, 0
    ds_read_b64_tr_b16 a[116:117], v8 offset:40960
    v_mfma_f32_16x16x32_bf16 v[72:75], a[68:71], v[168:171], v[72:75]
    ds_read_b64_tr_b16 a[122:123], v6 offset:26112
    v_mfma_f32_16x16x32_bf16 v[56:59], a[68:71], v[164:167], v[56:59]
    ds_read_b64_tr_b16 a[120:121], v6 offset:25600
    v_mfma_f32_16x16x32_bf16 v[56:59], a[64:67], v[160:163], v[56:59]
    ds_read_b64_tr_b16 a[126:127], v6 offset:34304
    v_mfma_f32_16x16x32_bf16 v[56:59], a[60:63], v[156:159], v[56:59]
    ds_read_b64_tr_b16 a[124:125], v6 offset:33792
    v_mfma_f32_16x16x32_bf16 v[40:43], a[60:63], v[152:155], v[40:43]
    buffer_load_dwordx4 v10, s[16:19], 0 offen offset:0 lds
    v_mfma_f32_16x16x32_bf16 v[40:43], a[64:67], v[156:159], v[40:43]
    ds_read_b64_tr_b16 a[130:131], v6 offset:42496
    v_mfma_f32_16x16x32_bf16 v[40:43], a[68:71], v[160:163], v[40:43]
    ds_read_b64_tr_b16 a[128:129], v6 offset:41984
    v_mfma_f32_16x16x32_bf16 v[24:27], a[68:71], v[156:159], v[24:27]
    ds_read_b64_tr_b16 a[134:135], v8 offset:26112
    v_mfma_f32_16x16x32_bf16 v[24:27], a[64:67], v[152:155], v[24:27]
    ds_read_b64_tr_b16 a[132:133], v8 offset:25600
    v_mfma_f32_16x16x32_bf16 v[24:27], a[60:63], v[148:151], v[24:27]
    ds_read_b64_tr_b16 a[138:139], v8 offset:34304
    v_mfma_f32_16x16x32_bf16 v[28:31], a[72:75], v[148:151], v[28:31]
    ds_read_b64_tr_b16 a[136:137], v8 offset:33792
    v_mfma_f32_16x16x32_bf16 v[28:31], a[76:79], v[152:155], v[28:31]
    buffer_load_dwordx4 v10, s[16:19], 0 offen offset:1024 lds
    v_mfma_f32_16x16x32_bf16 v[28:31], a[80:83], v[156:159], v[28:31]
    s_add_u32 m0, s72, s6
    ds_read_b64_tr_b16 a[142:143], v8 offset:42496
    v_mfma_f32_16x16x32_bf16 v[44:47], a[80:83], v[160:163], v[44:47]
    s_add_u32 s16, s69, s62
    s_addc_u32 s17, s29, 0
    ds_read_b64_tr_b16 a[140:141], v8 offset:41984
    v_mfma_f32_16x16x32_bf16 v[44:47], a[76:79], v[156:159], v[44:47]
    ds_read_b128 v[224:227], v17 offset:34816
    v_mfma_f32_16x16x32_bf16 v[44:47], a[72:75], v[152:155], v[44:47]
    ds_read_b128 v[220:223], v4 offset:32768
    v_mfma_f32_16x16x32_bf16 v[60:63], a[72:75], v[156:159], v[60:63]
    ds_read_b128 v[216:219], v2 offset:35584
    v_mfma_f32_16x16x32_bf16 v[60:63], a[76:79], v[160:163], v[60:63]
    ds_read_b128 v[212:215], v2 offset:33536
    v_mfma_f32_16x16x32_bf16 v[60:63], a[80:83], v[164:167], v[60:63]
    buffer_load_dwordx4 v10, s[16:19], 0 offen offset:0 lds
    v_mfma_f32_16x16x32_bf16 v[76:79], a[80:83], v[168:171], v[76:79]
    ds_read_b128 v[208:211], v2 offset:35328
    v_mfma_f32_16x16x32_bf16 v[76:79], a[76:79], v[164:167], v[76:79]
    ds_read_b128 v[204:207], v2 offset:33280
    v_mfma_f32_16x16x32_bf16 v[76:79], a[72:75], v[160:163], v[76:79]
    ds_read_b128 v[200:203], v2 offset:35072
    v_mfma_f32_16x16x32_bf16 v[92:95], a[72:75], v[164:167], v[92:95]
    ds_read_b128 v[196:199], v2 offset:33024
    v_mfma_f32_16x16x32_bf16 v[92:95], a[76:79], v[168:171], v[92:95]
    ds_read_b128 v[192:195], v2 offset:34816
    v_mfma_f32_16x16x32_bf16 v[92:95], a[80:83], v[172:175], v[92:95]
    ds_read_b128 v[188:191], v2 offset:32768
    v_mfma_f32_16x16x32_bf16 v[108:111], a[80:83], v[176:179], v[108:111]
    buffer_load_dwordx4 v10, s[16:19], 0 offen offset:1024 lds
    v_mfma_f32_16x16x32_bf16 v[108:111], a[76:79], v[172:175], v[108:111]
    s_add_u32 m0, s73, s6
    s_add_u32 s16, s70, s62
    s_addc_u32 s17, s31, 0
    v_mfma_f32_16x16x32_bf16 v[108:111], a[72:75], v[168:171], v[108:111]
    v_mfma_f32_16x16x32_bf16 v[124:127], a[72:75], v[172:175], v[124:127]
    v_mfma_f32_16x16x32_bf16 v[124:127], a[76:79], v[176:179], v[124:127]
    v_mfma_f32_16x16x32_bf16 v[124:127], a[80:83], v[180:183], v[124:127]
    v_mfma_f32_16x16x32_bf16 v[140:143], a[80:83], v[184:187], v[140:143]
    v_mfma_f32_16x16x32_bf16 v[140:143], a[76:79], v[180:183], v[140:143]
    buffer_load_dwordx4 v10, s[16:19], 0 offen offset:0 lds
    v_mfma_f32_16x16x32_bf16 v[140:143], a[72:75], v[176:179], v[140:143]
    s_waitcnt vmcnt(7) lgkmcnt(0)
    s_barrier
    v_mfma_f32_16x16x32_bf16 v[144:147], a[84:87], v[176:179], v[144:147]
    v_mfma_f32_16x16x32_bf16 v[144:147], a[88:91], v[180:183], v[144:147]
    v_mfma_f32_16x16x32_bf16 v[144:147], a[92:95], v[184:187], v[144:147]
    v_mfma_f32_16x16x32_bf16 v[128:131], a[92:95], v[180:183], v[128:131]
    v_mfma_f32_16x16x32_bf16 v[128:131], a[88:91], v[176:179], v[128:131]
    v_mfma_f32_16x16x32_bf16 v[128:131], a[84:87], v[172:175], v[128:131]
    buffer_load_dwordx4 v10, s[16:19], 0 offen offset:1024 lds
    v_mfma_f32_16x16x32_bf16 v[112:115], a[84:87], v[168:171], v[112:115]
    s_add_u32 m0, s74, s4
    s_lshr_b32 s32, s62, 10
    v_mfma_f32_16x16x32_bf16 v[112:115], a[88:91], v[172:175], v[112:115]
    s_add_u32 s12, s42, s32
    s_addc_u32 s13, s43, 0
    v_mfma_f32_16x16x32_bf16 v[112:115], a[92:95], v[176:179], v[112:115]
    v_mfma_f32_16x16x32_bf16 v[96:99], a[92:95], v[172:175], v[96:99]
    v_mfma_f32_16x16x32_bf16 v[96:99], a[88:91], v[168:171], v[96:99]
    v_mfma_f32_16x16x32_bf16 v[96:99], a[84:87], v[164:167], v[96:99]
    v_mfma_f32_16x16x32_bf16 v[80:83], a[84:87], v[160:163], v[80:83]
    buffer_load_dwordx4 v252, s[12:15], 0 offen offset:0 lds
    v_mfma_f32_16x16x32_bf16 v[80:83], a[88:91], v[164:167], v[80:83]
    v_mfma_f32_16x16x32_bf16 v[80:83], a[92:95], v[168:171], v[80:83]
    v_mfma_f32_16x16x32_bf16 v[64:67], a[92:95], v[164:167], v[64:67]
    v_mfma_f32_16x16x32_bf16 v[64:67], a[88:91], v[160:163], v[64:67]
    v_mfma_f32_16x16x32_bf16 v[64:67], a[84:87], v[156:159], v[64:67]
    v_mfma_f32_16x16x32_bf16 v[48:51], a[84:87], v[152:155], v[48:51]
    v_mfma_f32_16x16x32_bf16 v[48:51], a[88:91], v[156:159], v[48:51]
    buffer_load_dwordx4 v252, s[12:15], 0 offen offset:1024 lds
    v_mfma_f32_16x16x32_bf16 v[48:51], a[92:95], v[160:163], v[48:51]
    s_add_u32 m0, s75, s4
    v_mfma_f32_16x16x32_bf16 v[32:35], a[92:95], v[156:159], v[32:35]
    v_mfma_f32_16x16x32_bf16 v[32:35], a[88:91], v[152:155], v[32:35]
    v_mfma_f32_16x16x32_bf16 v[32:35], a[84:87], v[148:151], v[32:35]
    v_mfma_f32_16x16x32_bf16 v[20:23], a[96:99], v[188:191], v[20:23]
    v_mfma_f32_16x16x32_bf16 v[20:23], a[100:103], v[192:195], v[20:23]
    v_mfma_f32_16x16x32_bf16 v[20:23], a[104:107], v[196:199], v[20:23]
    buffer_load_dwordx4 v253, s[12:15], 0 offen offset:0 lds
    v_mfma_f32_16x16x32_bf16 v[36:39], a[104:107], v[200:203], v[36:39]
    v_mfma_f32_16x16x32_bf16 v[36:39], a[100:103], v[196:199], v[36:39]
    v_mfma_f32_16x16x32_bf16 v[36:39], a[96:99], v[192:195], v[36:39]
    v_mfma_f32_16x16x32_bf16 v[52:55], a[96:99], v[196:199], v[52:55]
    v_mfma_f32_16x16x32_bf16 v[52:55], a[100:103], v[200:203], v[52:55]
    ds_read_b64_tr_b16 a[146:147], v5 offset:512
    v_mfma_f32_16x16x32_bf16 v[52:55], a[104:107], v[204:207], v[52:55]
    ds_read_b64_tr_b16 a[144:145], v5 offset:0
    v_mfma_f32_16x16x32_bf16 v[68:71], a[104:107], v[208:211], v[68:71]
    buffer_load_dwordx4 v253, s[12:15], 0 offen offset:1024 lds
    v_mfma_f32_16x16x32_bf16 v[68:71], a[100:103], v[204:207], v[68:71]
    s_add_u32 m0, s76, s4
    ds_read_b64_tr_b16 a[150:151], v5 offset:8704
    v_mfma_f32_16x16x32_bf16 v[68:71], a[96:99], v[200:203], v[68:71]
    ds_read_b64_tr_b16 a[148:149], v5 offset:8192
    v_mfma_f32_16x16x32_bf16 v[84:87], a[96:99], v[204:207], v[84:87]
    ds_read_b64_tr_b16 a[154:155], v5 offset:16896
    v_mfma_f32_16x16x32_bf16 v[84:87], a[100:103], v[208:211], v[84:87]
    ds_read_b64_tr_b16 a[152:153], v5 offset:16384
    v_mfma_f32_16x16x32_bf16 v[84:87], a[104:107], v[212:215], v[84:87]
    ds_read_b64_tr_b16 a[158:159], v7 offset:512
    v_mfma_f32_16x16x32_bf16 v[100:103], a[104:107], v[216:219], v[100:103]
    ds_read_b64_tr_b16 a[156:157], v7 offset:0
    v_mfma_f32_16x16x32_bf16 v[100:103], a[100:103], v[212:215], v[100:103]
    buffer_load_dwordx4 v254, s[12:15], 0 offen offset:0 lds
    v_mfma_f32_16x16x32_bf16 v[100:103], a[96:99], v[208:211], v[100:103]
    ds_read_b64_tr_b16 a[162:163], v7 offset:8704
    v_mfma_f32_16x16x32_bf16 v[116:119], a[96:99], v[212:215], v[116:119]
    ds_read_b64_tr_b16 a[160:161], v7 offset:8192
    v_mfma_f32_16x16x32_bf16 v[116:119], a[100:103], v[216:219], v[116:119]
    ds_read_b64_tr_b16 a[166:167], v7 offset:16896
    v_mfma_f32_16x16x32_bf16 v[116:119], a[104:107], v[220:223], v[116:119]
    ds_read_b64_tr_b16 a[164:165], v7 offset:16384
    v_mfma_f32_16x16x32_bf16 v[132:135], a[104:107], v[224:227], v[132:135]
    ds_read_b64_tr_b16 a[170:171], v5 offset:1536
    v_mfma_f32_16x16x32_bf16 v[132:135], a[100:103], v[220:223], v[132:135]
    ds_read_b64_tr_b16 a[168:169], v5 offset:1024
    v_mfma_f32_16x16x32_bf16 v[132:135], a[96:99], v[216:219], v[132:135]
    buffer_load_dwordx4 v254, s[12:15], 0 offen offset:1024 lds
    v_mfma_f32_16x16x32_bf16 v[136:139], a[108:111], v[216:219], v[136:139]
    s_add_u32 m0, s77, s4
    ds_read_b64_tr_b16 a[174:175], v5 offset:9728
    v_mfma_f32_16x16x32_bf16 v[136:139], a[112:115], v[220:223], v[136:139]
    ds_read_b64_tr_b16 a[172:173], v5 offset:9216
    v_mfma_f32_16x16x32_bf16 v[136:139], a[116:119], v[224:227], v[136:139]
    ds_read_b64_tr_b16 a[178:179], v5 offset:17920
    v_mfma_f32_16x16x32_bf16 v[120:123], a[116:119], v[220:223], v[120:123]
    ds_read_b64_tr_b16 a[176:177], v5 offset:17408
    v_mfma_f32_16x16x32_bf16 v[120:123], a[112:115], v[216:219], v[120:123]
    ds_read_b64_tr_b16 a[182:183], v7 offset:1536
    v_mfma_f32_16x16x32_bf16 v[120:123], a[108:111], v[212:215], v[120:123]
    ds_read_b64_tr_b16 a[180:181], v7 offset:1024
    v_mfma_f32_16x16x32_bf16 v[104:107], a[108:111], v[208:211], v[104:107]
    buffer_load_dwordx4 v255, s[12:15], 0 offen offset:0 lds
    v_mfma_f32_16x16x32_bf16 v[104:107], a[112:115], v[212:215], v[104:107]
    ds_read_b64_tr_b16 a[186:187], v7 offset:9728
    v_mfma_f32_16x16x32_bf16 v[104:107], a[116:119], v[216:219], v[104:107]
    ds_read_b64_tr_b16 a[184:185], v7 offset:9216
    v_mfma_f32_16x16x32_bf16 v[88:91], a[116:119], v[212:215], v[88:91]
    ds_read_b64_tr_b16 a[190:191], v7 offset:17920
    v_mfma_f32_16x16x32_bf16 v[88:91], a[112:115], v[208:211], v[88:91]
    ds_read_b64_tr_b16 a[188:189], v7 offset:17408
    v_mfma_f32_16x16x32_bf16 v[88:91], a[108:111], v[204:207], v[88:91]
    ds_read_b64_tr_b16 a[194:195], v5 offset:25088
    v_mfma_f32_16x16x32_bf16 v[72:75], a[108:111], v[200:203], v[72:75]
    ds_read_b64_tr_b16 a[192:193], v5 offset:24576
    v_mfma_f32_16x16x32_bf16 v[72:75], a[112:115], v[204:207], v[72:75]
    buffer_load_dwordx4 v255, s[12:15], 0 offen offset:1024 lds
    v_mfma_f32_16x16x32_bf16 v[72:75], a[116:119], v[208:211], v[72:75]
    s_add_u32 m0, s71, s7
    ds_read_b64_tr_b16 a[198:199], v5 offset:33280
    v_mfma_f32_16x16x32_bf16 v[56:59], a[116:119], v[204:207], v[56:59]
    s_add_u32 s16, s68, s63
    s_addc_u32 s17, s28, 0
    ds_read_b64_tr_b16 a[196:197], v5 offset:32768
    v_mfma_f32_16x16x32_bf16 v[56:59], a[112:115], v[200:203], v[56:59]
    ds_read_b64_tr_b16 a[202:203], v5 offset:41472
    v_mfma_f32_16x16x32_bf16 v[56:59], a[108:111], v[196:199], v[56:59]
    ds_read_b64_tr_b16 a[200:201], v5 offset:40960
    v_mfma_f32_16x16x32_bf16 v[40:43], a[108:111], v[192:195], v[40:43]
    ds_read_b64_tr_b16 a[206:207], v7 offset:25088
    v_mfma_f32_16x16x32_bf16 v[40:43], a[112:115], v[196:199], v[40:43]
    ds_read_b64_tr_b16 a[204:205], v7 offset:24576
    v_mfma_f32_16x16x32_bf16 v[40:43], a[116:119], v[200:203], v[40:43]
    buffer_load_dwordx4 v10, s[16:19], 0 offen offset:0 lds
    v_mfma_f32_16x16x32_bf16 v[24:27], a[116:119], v[196:199], v[24:27]
    ds_read_b64_tr_b16 a[210:211], v7 offset:33280
    v_mfma_f32_16x16x32_bf16 v[24:27], a[112:115], v[192:195], v[24:27]
    ds_read_b64_tr_b16 a[208:209], v7 offset:32768
    v_mfma_f32_16x16x32_bf16 v[24:27], a[108:111], v[188:191], v[24:27]
    ds_read_b64_tr_b16 a[214:215], v7 offset:41472
    v_mfma_f32_16x16x32_bf16 v[28:31], a[120:123], v[188:191], v[28:31]
    ds_read_b64_tr_b16 a[212:213], v7 offset:40960
    v_mfma_f32_16x16x32_bf16 v[28:31], a[124:127], v[192:195], v[28:31]
    ds_read_b64_tr_b16 a[218:219], v5 offset:26112
    v_mfma_f32_16x16x32_bf16 v[28:31], a[128:131], v[196:199], v[28:31]
    ds_read_b64_tr_b16 a[216:217], v5 offset:25600
    v_mfma_f32_16x16x32_bf16 v[44:47], a[128:131], v[200:203], v[44:47]
    buffer_load_dwordx4 v10, s[16:19], 0 offen offset:1024 lds
    v_mfma_f32_16x16x32_bf16 v[44:47], a[124:127], v[196:199], v[44:47]
    s_add_u32 m0, s72, s7
    ds_read_b64_tr_b16 a[222:223], v5 offset:34304
    v_mfma_f32_16x16x32_bf16 v[44:47], a[120:123], v[192:195], v[44:47]
    s_add_u32 s16, s69, s63
    s_addc_u32 s17, s29, 0
    ds_read_b64_tr_b16 a[220:221], v5 offset:33792
    v_mfma_f32_16x16x32_bf16 v[60:63], a[120:123], v[196:199], v[60:63]
    ds_read_b64_tr_b16 a[226:227], v5 offset:42496
    v_mfma_f32_16x16x32_bf16 v[60:63], a[124:127], v[200:203], v[60:63]
    ds_read_b64_tr_b16 a[224:225], v5 offset:41984
    v_mfma_f32_16x16x32_bf16 v[60:63], a[128:131], v[204:207], v[60:63]
    ds_read_b64_tr_b16 a[230:231], v7 offset:26112
    v_mfma_f32_16x16x32_bf16 v[76:79], a[128:131], v[208:211], v[76:79]
    ds_read_b64_tr_b16 a[228:229], v7 offset:25600
    v_mfma_f32_16x16x32_bf16 v[76:79], a[124:127], v[204:207], v[76:79]
    buffer_load_dwordx4 v10, s[16:19], 0 offen offset:0 lds
    v_mfma_f32_16x16x32_bf16 v[76:79], a[120:123], v[200:203], v[76:79]
    ds_read_b64_tr_b16 a[234:235], v7 offset:34304
    v_mfma_f32_16x16x32_bf16 v[92:95], a[120:123], v[204:207], v[92:95]
    ds_read_b64_tr_b16 a[232:233], v7 offset:33792
    v_mfma_f32_16x16x32_bf16 v[92:95], a[124:127], v[208:211], v[92:95]
    ds_read_b64_tr_b16 a[238:239], v7 offset:42496
    v_mfma_f32_16x16x32_bf16 v[92:95], a[128:131], v[212:215], v[92:95]
    ds_read_b64_tr_b16 a[236:237], v7 offset:41984
    v_mfma_f32_16x16x32_bf16 v[108:111], a[128:131], v[216:219], v[108:111]
    v_mfma_f32_16x16x32_bf16 v[108:111], a[124:127], v[212:215], v[108:111]
    v_mfma_f32_16x16x32_bf16 v[108:111], a[120:123], v[208:211], v[108:111]
    buffer_load_dwordx4 v10, s[16:19], 0 offen offset:1024 lds
    v_mfma_f32_16x16x32_bf16 v[124:127], a[120:123], v[212:215], v[124:127]
    s_add_u32 m0, s73, s7
    s_add_u32 s16, s70, s63
    s_addc_u32 s17, s31, 0
    v_mfma_f32_16x16x32_bf16 v[124:127], a[124:127], v[216:219], v[124:127]
    v_mfma_f32_16x16x32_bf16 v[124:127], a[128:131], v[220:223], v[124:127]
    v_mfma_f32_16x16x32_bf16 v[140:143], a[128:131], v[224:227], v[140:143]
    v_mfma_f32_16x16x32_bf16 v[140:143], a[124:127], v[220:223], v[140:143]
    v_mfma_f32_16x16x32_bf16 v[140:143], a[120:123], v[216:219], v[140:143]
    s_waitcnt vmcnt(12) lgkmcnt(0)
    s_barrier
    v_mfma_f32_16x16x32_bf16 v[144:147], a[132:135], v[216:219], v[144:147]
    buffer_load_dwordx4 v10, s[16:19], 0 offen offset:0 lds
    v_mfma_f32_16x16x32_bf16 v[144:147], a[136:139], v[220:223], v[144:147]
    v_mfma_f32_16x16x32_bf16 v[144:147], a[140:143], v[224:227], v[144:147]
    v_mfma_f32_16x16x32_bf16 v[128:131], a[140:143], v[220:223], v[128:131]
    v_mfma_f32_16x16x32_bf16 v[128:131], a[136:139], v[216:219], v[128:131]
    v_mfma_f32_16x16x32_bf16 v[128:131], a[132:135], v[212:215], v[128:131]
    v_mfma_f32_16x16x32_bf16 v[112:115], a[132:135], v[208:211], v[112:115]
    v_mfma_f32_16x16x32_bf16 v[112:115], a[136:139], v[212:215], v[112:115]
    buffer_load_dwordx4 v10, s[16:19], 0 offen offset:1024 lds
    v_mfma_f32_16x16x32_bf16 v[112:115], a[140:143], v[216:219], v[112:115]
    s_mov_b32 m0, s71
    s_add_u32 s16, s68, s64
    s_addc_u32 s17, s28, 0
    v_mfma_f32_16x16x32_bf16 v[96:99], a[140:143], v[212:215], v[96:99]
    v_mfma_f32_16x16x32_bf16 v[96:99], a[136:139], v[208:211], v[96:99]
    v_mfma_f32_16x16x32_bf16 v[96:99], a[132:135], v[204:207], v[96:99]
    v_mfma_f32_16x16x32_bf16 v[80:83], a[132:135], v[200:203], v[80:83]
    v_mfma_f32_16x16x32_bf16 v[80:83], a[136:139], v[204:207], v[80:83]
    ds_read_b128 v[148:151], v1 offset:0
    v_mfma_f32_16x16x32_bf16 v[80:83], a[140:143], v[208:211], v[80:83]
    buffer_load_dwordx4 v10, s[16:19], 0 offen offset:0 lds
    v_mfma_f32_16x16x32_bf16 v[64:67], a[140:143], v[204:207], v[64:67]
    ds_read_b128 v[152:155], v1 offset:2048
    v_mfma_f32_16x16x32_bf16 v[64:67], a[136:139], v[200:203], v[64:67]
    ds_read_b128 v[156:159], v1 offset:256
    v_mfma_f32_16x16x32_bf16 v[64:67], a[132:135], v[196:199], v[64:67]
    ds_read_b128 v[160:163], v1 offset:2304
    v_mfma_f32_16x16x32_bf16 v[48:51], a[132:135], v[192:195], v[48:51]
    v_mfma_f32_16x16x32_bf16 v[48:51], a[136:139], v[196:199], v[48:51]
    v_mfma_f32_16x16x32_bf16 v[48:51], a[140:143], v[200:203], v[48:51]
    v_mfma_f32_16x16x32_bf16 v[32:35], a[140:143], v[196:199], v[32:35]
    buffer_load_dwordx4 v10, s[16:19], 0 offen offset:1024 lds
    v_mfma_f32_16x16x32_bf16 v[32:35], a[136:139], v[192:195], v[32:35]
    s_mov_b32 m0, s72
    ds_read_b128 v[164:167], v1 offset:512
    v_mfma_f32_16x16x32_bf16 v[32:35], a[132:135], v[188:191], v[32:35]
    s_waitcnt lgkmcnt(2)
    ds_read_b128 v[168:171], v1 offset:2560
    v_mfma_f32_16x16x32_bf16 v[20:23], a[144:147], v[148:151], v[20:23]
    s_add_u32 s16, s69, s64
    s_addc_u32 s17, s29, 0
    v_mfma_f32_16x16x32_bf16 v[20:23], a[148:151], v[152:155], v[20:23]
    v_mfma_f32_16x16x32_bf16 v[20:23], a[152:155], v[156:159], v[20:23]
    s_waitcnt lgkmcnt(2)
    v_mfma_f32_16x16x32_bf16 v[36:39], a[152:155], v[160:163], v[36:39]
    ds_read_b128 v[172:175], v1 offset:768
    v_mfma_f32_16x16x32_bf16 v[36:39], a[148:151], v[156:159], v[36:39]
    buffer_load_dwordx4 v10, s[16:19], 0 offen offset:0 lds
    v_mfma_f32_16x16x32_bf16 v[36:39], a[144:147], v[152:155], v[36:39]
    ds_read_b128 v[176:179], v1 offset:2816
    v_mfma_f32_16x16x32_bf16 v[52:55], a[144:147], v[156:159], v[52:55]
    v_mfma_f32_16x16x32_bf16 v[52:55], a[148:151], v[160:163], v[52:55]
    s_waitcnt lgkmcnt(2)
    v_mfma_f32_16x16x32_bf16 v[52:55], a[152:155], v[164:167], v[52:55]
    v_mfma_f32_16x16x32_bf16 v[68:71], a[152:155], v[168:171], v[68:71]
    ds_read_b128 v[180:183], v3 offset:0
    v_mfma_f32_16x16x32_bf16 v[68:71], a[148:151], v[164:167], v[68:71]
    ds_read_b128 v[184:187], v16 offset:2048
    v_mfma_f32_16x16x32_bf16 v[68:71], a[144:147], v[160:163], v[68:71]
    buffer_load_dwordx4 v10, s[16:19], 0 offen offset:1024 lds
    v_mfma_f32_16x16x32_bf16 v[84:87], a[144:147], v[164:167], v[84:87]
    s_mov_b32 m0, s73
    s_add_u32 s16, s70, s64
    s_addc_u32 s17, s31, 0
    v_mfma_f32_16x16x32_bf16 v[84:87], a[148:151], v[168:171], v[84:87]
    s_waitcnt lgkmcnt(2)
    v_mfma_f32_16x16x32_bf16 v[84:87], a[152:155], v[172:175], v[84:87]
    v_mfma_f32_16x16x32_bf16 v[100:103], a[152:155], v[176:179], v[100:103]
    v_mfma_f32_16x16x32_bf16 v[100:103], a[148:151], v[172:175], v[100:103]
    v_mfma_f32_16x16x32_bf16 v[100:103], a[144:147], v[168:171], v[100:103]
    v_mfma_f32_16x16x32_bf16 v[116:119], a[144:147], v[172:175], v[116:119]
    buffer_load_dwordx4 v10, s[16:19], 0 offen offset:0 lds
    v_mfma_f32_16x16x32_bf16 v[116:119], a[148:151], v[176:179], v[116:119]
    s_waitcnt lgkmcnt(0)
    v_mfma_f32_16x16x32_bf16 v[116:119], a[152:155], v[180:183], v[116:119]
    v_mfma_f32_16x16x32_bf16 v[132:135], a[152:155], v[184:187], v[132:135]
    v_mfma_f32_16x16x32_bf16 v[132:135], a[148:151], v[180:183], v[132:135]
    v_mfma_f32_16x16x32_bf16 v[132:135], a[144:147], v[176:179], v[132:135]
    ds_read_b64_tr_b16 a[2:3], v6 offset:512
    v_mfma_f32_16x16x32_bf16 v[136:139], a[156:159], v[176:179], v[136:139]
    ds_read_b64_tr_b16 a[0:1], v6 offset:0
    v_mfma_f32_16x16x32_bf16 v[136:139], a[160:163], v[180:183], v[136:139]
    buffer_load_dwordx4 v10, s[16:19], 0 offen offset:1024 lds
    v_mfma_f32_16x16x32_bf16 v[136:139], a[164:167], v[184:187], v[136:139]
    s_add_u32 m0, s71, s5
    ds_read_b64_tr_b16 a[6:7], v6 offset:8704
    v_mfma_f32_16x16x32_bf16 v[120:123], a[164:167], v[180:183], v[120:123]
    s_add_u32 s16, s68, s65
    s_addc_u32 s17, s28, 0
    ds_read_b64_tr_b16 a[4:5], v6 offset:8192
    v_mfma_f32_16x16x32_bf16 v[120:123], a[160:163], v[176:179], v[120:123]
    ds_read_b64_tr_b16 a[10:11], v6 offset:16896
    v_mfma_f32_16x16x32_bf16 v[120:123], a[156:159], v[172:175], v[120:123]
    ds_read_b64_tr_b16 a[8:9], v6 offset:16384
    v_mfma_f32_16x16x32_bf16 v[104:107], a[156:159], v[168:171], v[104:107]
    ds_read_b64_tr_b16 a[14:15], v8 offset:512
    v_mfma_f32_16x16x32_bf16 v[104:107], a[160:163], v[172:175], v[104:107]
    ds_read_b64_tr_b16 a[12:13], v8 offset:0
    v_mfma_f32_16x16x32_bf16 v[104:107], a[164:167], v[176:179], v[104:107]
    buffer_load_dwordx4 v10, s[16:19], 0 offen offset:0 lds
    v_mfma_f32_16x16x32_bf16 v[88:91], a[164:167], v[172:175], v[88:91]
    ds_read_b64_tr_b16 a[18:19], v8 offset:8704
    v_mfma_f32_16x16x32_bf16 v[88:91], a[160:163], v[168:171], v[88:91]
    ds_read_b64_tr_b16 a[16:17], v8 offset:8192
    v_mfma_f32_16x16x32_bf16 v[88:91], a[156:159], v[164:167], v[88:91]
    ds_read_b64_tr_b16 a[22:23], v8 offset:16896
    v_mfma_f32_16x16x32_bf16 v[72:75], a[156:159], v[160:163], v[72:75]
    ds_read_b64_tr_b16 a[20:21], v8 offset:16384
    v_mfma_f32_16x16x32_bf16 v[72:75], a[160:163], v[164:167], v[72:75]
    ds_read_b64_tr_b16 a[26:27], v6 offset:1536
    v_mfma_f32_16x16x32_bf16 v[72:75], a[164:167], v[168:171], v[72:75]
    ds_read_b64_tr_b16 a[24:25], v6 offset:1024
    v_mfma_f32_16x16x32_bf16 v[56:59], a[164:167], v[164:167], v[56:59]
    buffer_load_dwordx4 v10, s[16:19], 0 offen offset:1024 lds
    v_mfma_f32_16x16x32_bf16 v[56:59], a[160:163], v[160:163], v[56:59]
    s_add_u32 m0, s72, s5
    ds_read_b64_tr_b16 a[30:31], v6 offset:9728
    v_mfma_f32_16x16x32_bf16 v[56:59], a[156:159], v[156:159], v[56:59]
    s_add_u32 s16, s69, s65
    s_addc_u32 s17, s29, 0
    ds_read_b64_tr_b16 a[28:29], v6 offset:9216
    v_mfma_f32_16x16x32_bf16 v[40:43], a[156:159], v[152:155], v[40:43]
    ds_read_b64_tr_b16 a[34:35], v6 offset:17920
    v_mfma_f32_16x16x32_bf16 v[40:43], a[160:163], v[156:159], v[40:43]
    ds_read_b64_tr_b16 a[32:33], v6 offset:17408
    v_mfma_f32_16x16x32_bf16 v[40:43], a[164:167], v[160:163], v[40:43]
    ds_read_b64_tr_b16 a[38:39], v8 offset:1536
    v_mfma_f32_16x16x32_bf16 v[24:27], a[164:167], v[156:159], v[24:27]
    ds_read_b64_tr_b16 a[36:37], v8 offset:1024
    v_mfma_f32_16x16x32_bf16 v[24:27], a[160:163], v[152:155], v[24:27]
    buffer_load_dwordx4 v10, s[16:19], 0 offen offset:0 lds
    v_mfma_f32_16x16x32_bf16 v[24:27], a[156:159], v[148:151], v[24:27]
    ds_read_b64_tr_b16 a[42:43], v8 offset:9728
    v_mfma_f32_16x16x32_bf16 v[28:31], a[168:171], v[148:151], v[28:31]
    ds_read_b64_tr_b16 a[40:41], v8 offset:9216
    v_mfma_f32_16x16x32_bf16 v[28:31], a[172:175], v[152:155], v[28:31]
    ds_read_b64_tr_b16 a[46:47], v8 offset:17920
    v_mfma_f32_16x16x32_bf16 v[28:31], a[176:179], v[156:159], v[28:31]
    ds_read_b64_tr_b16 a[44:45], v8 offset:17408
    v_mfma_f32_16x16x32_bf16 v[44:47], a[176:179], v[160:163], v[44:47]
    ds_read_b128 v[224:227], v17 offset:2048
    v_mfma_f32_16x16x32_bf16 v[44:47], a[172:175], v[156:159], v[44:47]
    ds_read_b128 v[220:223], v4 offset:0
    v_mfma_f32_16x16x32_bf16 v[44:47], a[168:171], v[152:155], v[44:47]
    buffer_load_dwordx4 v10, s[16:19], 0 offen offset:1024 lds
    v_mfma_f32_16x16x32_bf16 v[60:63], a[168:171], v[156:159], v[60:63]
    s_add_u32 m0, s73, s5
    ds_read_b128 v[216:219], v2 offset:2816
    v_mfma_f32_16x16x32_bf16 v[60:63], a[172:175], v[160:163], v[60:63]
    s_add_u32 s16, s70, s65
    s_addc_u32 s17, s31, 0
    ds_read_b128 v[212:215], v2 offset:768
    v_mfma_f32_16x16x32_bf16 v[60:63], a[176:179], v[164:167], v[60:63]
    ds_read_b128 v[208:211], v2 offset:2560
    v_mfma_f32_16x16x32_bf16 v[76:79], a[176:179], v[168:171], v[76:79]
    ds_read_b128 v[204:207], v2 offset:512
    v_mfma_f32_16x16x32_bf16 v[76:79], a[172:175], v[164:167], v[76:79]
    ds_read_b128 v[200:203], v2 offset:2304
    v_mfma_f32_16x16x32_bf16 v[76:79], a[168:171], v[160:163], v[76:79]
    ds_read_b128 v[196:199], v2 offset:256
    v_mfma_f32_16x16x32_bf16 v[92:95], a[168:171], v[164:167], v[92:95]
    buffer_load_dwordx4 v10, s[16:19], 0 offen offset:0 lds
    v_mfma_f32_16x16x32_bf16 v[92:95], a[172:175], v[168:171], v[92:95]
    ds_read_b128 v[192:195], v2 offset:2048
    v_mfma_f32_16x16x32_bf16 v[92:95], a[176:179], v[172:175], v[92:95]
    ds_read_b128 v[188:191], v2 offset:0
    v_mfma_f32_16x16x32_bf16 v[108:111], a[176:179], v[176:179], v[108:111]
    v_mfma_f32_16x16x32_bf16 v[108:111], a[172:175], v[172:175], v[108:111]
    v_mfma_f32_16x16x32_bf16 v[108:111], a[168:171], v[168:171], v[108:111]
    v_mfma_f32_16x16x32_bf16 v[124:127], a[168:171], v[172:175], v[124:127]
    v_mfma_f32_16x16x32_bf16 v[124:127], a[172:175], v[176:179], v[124:127]
    buffer_load_dwordx4 v10, s[16:19], 0 offen offset:1024 lds
    v_mfma_f32_16x16x32_bf16 v[124:127], a[176:179], v[180:183], v[124:127]
    s_mov_b32 m0, s74
    s_lshr_b32 s32, s64, 10
    v_mfma_f32_16x16x32_bf16 v[140:143], a[176:179], v[184:187], v[140:143]
    s_add_u32 s12, s42, s32
    s_addc_u32 s13, s43, 0
    v_mfma_f32_16x16x32_bf16 v[140:143], a[172:175], v[180:183], v[140:143]
    v_mfma_f32_16x16x32_bf16 v[140:143], a[168:171], v[176:179], v[140:143]
    s_waitcnt vmcnt(12) lgkmcnt(0)
    s_barrier
    v_mfma_f32_16x16x32_bf16 v[144:147], a[180:183], v[176:179], v[144:147]
    v_mfma_f32_16x16x32_bf16 v[144:147], a[184:187], v[180:183], v[144:147]
    v_mfma_f32_16x16x32_bf16 v[144:147], a[188:191], v[184:187], v[144:147]
    buffer_load_dwordx4 v252, s[12:15], 0 offen offset:0 lds
    v_mfma_f32_16x16x32_bf16 v[128:131], a[188:191], v[180:183], v[128:131]
    v_mfma_f32_16x16x32_bf16 v[128:131], a[184:187], v[176:179], v[128:131]
    v_mfma_f32_16x16x32_bf16 v[128:131], a[180:183], v[172:175], v[128:131]
    v_mfma_f32_16x16x32_bf16 v[112:115], a[180:183], v[168:171], v[112:115]
    v_mfma_f32_16x16x32_bf16 v[112:115], a[184:187], v[172:175], v[112:115]
    v_mfma_f32_16x16x32_bf16 v[112:115], a[188:191], v[176:179], v[112:115]
    buffer_load_dwordx4 v252, s[12:15], 0 offen offset:1024 lds
    v_mfma_f32_16x16x32_bf16 v[96:99], a[188:191], v[172:175], v[96:99]
    s_mov_b32 m0, s75
    v_mfma_f32_16x16x32_bf16 v[96:99], a[184:187], v[168:171], v[96:99]
    v_mfma_f32_16x16x32_bf16 v[96:99], a[180:183], v[164:167], v[96:99]
    v_mfma_f32_16x16x32_bf16 v[80:83], a[180:183], v[160:163], v[80:83]
    v_mfma_f32_16x16x32_bf16 v[80:83], a[184:187], v[164:167], v[80:83]
    v_mfma_f32_16x16x32_bf16 v[80:83], a[188:191], v[168:171], v[80:83]
    buffer_load_dwordx4 v253, s[12:15], 0 offen offset:0 lds
    v_mfma_f32_16x16x32_bf16 v[64:67], a[188:191], v[164:167], v[64:67]
    v_mfma_f32_16x16x32_bf16 v[64:67], a[184:187], v[160:163], v[64:67]
    v_mfma_f32_16x16x32_bf16 v[64:67], a[180:183], v[156:159], v[64:67]
    v_mfma_f32_16x16x32_bf16 v[48:51], a[180:183], v[152:155], v[48:51]
    v_mfma_f32_16x16x32_bf16 v[48:51], a[184:187], v[156:159], v[48:51]
    v_mfma_f32_16x16x32_bf16 v[48:51], a[188:191], v[160:163], v[48:51]
    buffer_load_dwordx4 v253, s[12:15], 0 offen offset:1024 lds
    v_mfma_f32_16x16x32_bf16 v[32:35], a[188:191], v[156:159], v[32:35]
    s_mov_b32 m0, s76
    v_mfma_f32_16x16x32_bf16 v[32:35], a[184:187], v[152:155], v[32:35]
    v_mfma_f32_16x16x32_bf16 v[32:35], a[180:183], v[148:151], v[32:35]
    v_mfma_f32_16x16x32_bf16 v[20:23], a[192:195], v[188:191], v[20:23]
    v_mfma_f32_16x16x32_bf16 v[20:23], a[196:199], v[192:195], v[20:23]
    v_mfma_f32_16x16x32_bf16 v[20:23], a[200:203], v[196:199], v[20:23]
    buffer_load_dwordx4 v254, s[12:15], 0 offen offset:0 lds
    v_mfma_f32_16x16x32_bf16 v[36:39], a[200:203], v[200:203], v[36:39]
    v_mfma_f32_16x16x32_bf16 v[36:39], a[196:199], v[196:199], v[36:39]
    v_mfma_f32_16x16x32_bf16 v[36:39], a[192:195], v[192:195], v[36:39]
    v_mfma_f32_16x16x32_bf16 v[52:55], a[192:195], v[196:199], v[52:55]
    v_mfma_f32_16x16x32_bf16 v[52:55], a[196:199], v[200:203], v[52:55]
    v_mfma_f32_16x16x32_bf16 v[52:55], a[200:203], v[204:207], v[52:55]
    buffer_load_dwordx4 v254, s[12:15], 0 offen offset:1024 lds
    v_mfma_f32_16x16x32_bf16 v[68:71], a[200:203], v[208:211], v[68:71]
    s_mov_b32 m0, s77
    v_mfma_f32_16x16x32_bf16 v[68:71], a[196:199], v[204:207], v[68:71]
    v_mfma_f32_16x16x32_bf16 v[68:71], a[192:195], v[200:203], v[68:71]
    ds_read_b64_tr_b16 a[50:51], v6 offset:25088
    v_mfma_f32_16x16x32_bf16 v[84:87], a[192:195], v[204:207], v[84:87]
    ds_read_b64_tr_b16 a[48:49], v6 offset:24576
    v_mfma_f32_16x16x32_bf16 v[84:87], a[196:199], v[208:211], v[84:87]
    ds_read_b128 v[228:231], v2 offset:32768
    v_mfma_f32_16x16x32_bf16 v[84:87], a[200:203], v[212:215], v[84:87]
    buffer_load_dwordx4 v255, s[12:15], 0 offen offset:0 lds
    v_mfma_f32_16x16x32_bf16 v[100:103], a[200:203], v[216:219], v[100:103]
    ds_read_b64_tr_b16 a[54:55], v6 offset:33280
    v_mfma_f32_16x16x32_bf16 v[100:103], a[196:199], v[212:215], v[100:103]
    ds_read_b64_tr_b16 a[52:53], v6 offset:32768
    v_mfma_f32_16x16x32_bf16 v[100:103], a[192:195], v[208:211], v[100:103]
    ds_read_b128 v[232:235], v2 offset:34816
    v_mfma_f32_16x16x32_bf16 v[116:119], a[192:195], v[212:215], v[116:119]
    ds_read_b64_tr_b16 a[58:59], v6 offset:41472
    v_mfma_f32_16x16x32_bf16 v[116:119], a[196:199], v[216:219], v[116:119]
    ds_read_b64_tr_b16 a[56:57], v6 offset:40960
    v_mfma_f32_16x16x32_bf16 v[116:119], a[200:203], v[220:223], v[116:119]
    buffer_load_dwordx4 v255, s[12:15], 0 offen offset:1024 lds
    v_mfma_f32_16x16x32_bf16 v[132:135], a[200:203], v[224:227], v[132:135]
    s_add_u32 m0, s71, s6
    ds_read_b128 v[236:239], v2 offset:33024
    v_mfma_f32_16x16x32_bf16 v[132:135], a[196:199], v[220:223], v[132:135]
    s_add_u32 s16, s68, s66
    s_addc_u32 s17, s28, 0
    ds_read_b64_tr_b16 a[70:71], v8 offset:41472
    v_mfma_f32_16x16x32_bf16 v[132:135], a[192:195], v[216:219], v[132:135]
    ds_read_b64_tr_b16 a[68:69], v8 offset:40960
    v_mfma_f32_16x16x32_bf16 v[136:139], a[204:207], v[216:219], v[136:139]
    ds_read_b64_tr_b16 a[66:67], v8 offset:33280
    v_mfma_f32_16x16x32_bf16 v[136:139], a[208:211], v[220:223], v[136:139]
    ds_read_b64_tr_b16 a[64:65], v8 offset:32768
    v_mfma_f32_16x16x32_bf16 v[136:139], a[212:215], v[224:227], v[136:139]
    buffer_load_dwordx4 v10, s[16:19], 0 offen offset:0 lds
    v_mfma_f32_16x16x32_bf16 v[120:123], a[212:215], v[220:223], v[120:123]
    ds_read_b64_tr_b16 a[62:63], v8 offset:25088
    v_mfma_f32_16x16x32_bf16 v[120:123], a[208:211], v[216:219], v[120:123]
    ds_read_b64_tr_b16 a[60:61], v8 offset:24576
    v_mfma_f32_16x16x32_bf16 v[120:123], a[204:207], v[212:215], v[120:123]
    ds_read_b64_tr_b16 a[74:75], v6 offset:26112
    v_mfma_f32_16x16x32_bf16 v[104:107], a[204:207], v[208:211], v[104:107]
    ds_read_b64_tr_b16 a[72:73], v6 offset:25600
    v_mfma_f32_16x16x32_bf16 v[104:107], a[208:211], v[212:215], v[104:107]
    ds_read_b64_tr_b16 a[78:79], v6 offset:34304
    v_mfma_f32_16x16x32_bf16 v[104:107], a[212:215], v[216:219], v[104:107]
    buffer_load_dwordx4 v10, s[16:19], 0 offen offset:1024 lds
    v_mfma_f32_16x16x32_bf16 v[88:91], a[212:215], v[212:215], v[88:91]
    s_add_u32 m0, s72, s6
    ds_read_b64_tr_b16 a[76:77], v6 offset:33792
    v_mfma_f32_16x16x32_bf16 v[88:91], a[208:211], v[208:211], v[88:91]
    s_add_u32 s16, s69, s66
    s_addc_u32 s17, s29, 0
    ds_read_b64_tr_b16 a[82:83], v6 offset:42496
    v_mfma_f32_16x16x32_bf16 v[88:91], a[204:207], v[204:207], v[88:91]
L_pg2:
    s_cmp_eq_u32 s30, 1
    s_cbranch_scc1 L_warm_ret
    ds_read_b64_tr_b16 a[80:81], v6 offset:41984
    v_mfma_f32_16x16x32_bf16 v[72:75], a[204:207], v[200:203], v[72:75]
    ds_read_b64_tr_b16 a[94:95], v8 offset:42496
    v_mfma_f32_16x16x32_bf16 v[72:75], a[208:211], v[204:207], v[72:75]
    ds_read_b64_tr_b16 a[92:93], v8 offset:41984
    v_mfma_f32_16x16x32_bf16 v[72:75], a[212:215], v[208:211], v[72:75]
    buffer_load_dwordx4 v10, s[16:19], 0 offen offset:0 lds
    v_mfma_f32_16x16x32_bf16 v[56:59], a[212:215], v[204:207], v[56:59]
    ds_read_b64_tr_b16 a[90:91], v8 offset:34304
    v_mfma_f32_16x16x32_bf16 v[56:59], a[208:211], v[200:203], v[56:59]
    ds_read_b64_tr_b16 a[88:89], v8 offset:33792
    v_mfma_f32_16x16x32_bf16 v[56:59], a[204:207], v[196:199], v[56:59]
    ds_read_b64_tr_b16 a[86:87], v8 offset:26112
    v_mfma_f32_16x16x32_bf16 v[40:43], a[204:207], v[192:195], v[40:43]
    ds_read_b64_tr_b16 a[84:85], v8 offset:25600
    v_mfma_f32_16x16x32_bf16 v[40:43], a[208:211], v[196:199], v[40:43]
    ds_read_b128 v[240:243], v2 offset:35072
    v_mfma_f32_16x16x32_bf16 v[40:43], a[212:215], v[200:203], v[40:43]
    buffer_load_dwordx4 v10, s[16:19], 0 offen offset:1024 lds
    v_mfma_f32_16x16x32_bf16 v[24:27], a[212:215], v[196:199], v[24:27]
    s_add_u32 m0, s73, s6
    ds_read_b128 v[244:247], v2 offset:33280
    v_mfma_f32_16x16x32_bf16 v[24:27], a[208:211], v[192:195], v[24:27]
    s_add_u32 s16, s70, s66
    s_addc_u32 s17, s31, 0
    ds_read_b128 v[248:251], v2 offset:35328
    v_mfma_f32_16x16x32_bf16 v[24:27], a[204:207], v[188:191], v[24:27]
    ds_read_b128 a[240:243], v2 offset:33536
    v_mfma_f32_16x16x32_bf16 v[28:31], a[216:219], v[188:191], v[28:31]
    ds_read_b128 a[244:247], v2 offset:35584
    v_mfma_f32_16x16x32_bf16 v[28:31], a[220:223], v[192:195], v[28:31]
    ds_read_b128 a[248:251], v4 offset:32768
    v_mfma_f32_16x16x32_bf16 v[28:31], a[224:227], v[196:199], v[28:31]
    buffer_load_dwordx4 v10, s[16:19], 0 offen offset:0 lds
    v_mfma_f32_16x16x32_bf16 v[44:47], a[224:227], v[200:203], v[44:47]
    ds_read_b128 a[252:255], v17 offset:34816
    v_mfma_f32_16x16x32_bf16 v[44:47], a[220:223], v[196:199], v[44:47]
    ds_read_b128 v[184:187], v16 offset:34816
    v_mfma_f32_16x16x32_bf16 v[44:47], a[216:219], v[192:195], v[44:47]
    ds_read_b128 v[180:183], v3 offset:32768
    v_mfma_f32_16x16x32_bf16 v[60:63], a[216:219], v[196:199], v[60:63]
    ds_read_b128 v[176:179], v1 offset:35584
    v_mfma_f32_16x16x32_bf16 v[60:63], a[220:223], v[200:203], v[60:63]
    ds_read_b128 v[172:175], v1 offset:33536
    v_mfma_f32_16x16x32_bf16 v[60:63], a[224:227], v[204:207], v[60:63]
    buffer_load_dwordx4 v10, s[16:19], 0 offen offset:1024 lds
    v_mfma_f32_16x16x32_bf16 v[76:79], a[224:227], v[208:211], v[76:79]
    s_add_u32 m0, s74, s4
    ds_read_b128 v[168:171], v1 offset:35328
    s_lshr_b32 s32, s66, 10
    v_mfma_f32_16x16x32_bf16 v[76:79], a[220:223], v[204:207], v[76:79]
    s_add_u32 s12, s42, s32
    s_addc_u32 s13, s43, 0
    ds_read_b128 v[164:167], v1 offset:33280
    v_mfma_f32_16x16x32_bf16 v[76:79], a[216:219], v[200:203], v[76:79]
    ds_read_b128 v[160:163], v1 offset:35072
    v_mfma_f32_16x16x32_bf16 v[92:95], a[216:219], v[204:207], v[92:95]
    ds_read_b128 v[156:159], v1 offset:33024
    v_mfma_f32_16x16x32_bf16 v[92:95], a[220:223], v[208:211], v[92:95]
    ds_read_b128 v[152:155], v1 offset:34816
    v_mfma_f32_16x16x32_bf16 v[92:95], a[224:227], v[212:215], v[92:95]
    ds_read_b128 v[148:151], v1 offset:32768
    v_mfma_f32_16x16x32_bf16 v[108:111], a[224:227], v[216:219], v[108:111]
    v_mfma_f32_16x16x32_bf16 v[108:111], a[220:223], v[212:215], v[108:111]
    v_mfma_f32_16x16x32_bf16 v[108:111], a[216:219], v[208:211], v[108:111]
    v_mfma_f32_16x16x32_bf16 v[124:127], a[216:219], v[212:215], v[124:127]
    v_mfma_f32_16x16x32_bf16 v[124:127], a[220:223], v[216:219], v[124:127]
    v_mfma_f32_16x16x32_bf16 v[124:127], a[224:227], v[220:223], v[124:127]
    v_mfma_f32_16x16x32_bf16 v[140:143], a[224:227], v[224:227], v[140:143]
    v_mfma_f32_16x16x32_bf16 v[140:143], a[220:223], v[220:223], v[140:143]
    v_mfma_f32_16x16x32_bf16 v[140:143], a[216:219], v[216:219], v[140:143]
    s_waitcnt vmcnt(20) lgkmcnt(0)
    s_barrier
    v_mfma_f32_16x16x32_bf16 v[144:147], a[228:231], v[216:219], v[144:147]
    v_mfma_f32_16x16x32_bf16 v[144:147], a[232:235], v[220:223], v[144:147]
    buffer_load_dwordx4 v252, s[12:15], 0 offen offset:0 lds
    v_mfma_f32_16x16x32_bf16 v[144:147], a[236:239], v[224:227], v[144:147]
    v_mfma_f32_16x16x32_bf16 v[128:131], a[236:239], v[220:223], v[128:131]
    v_mfma_f32_16x16x32_bf16 v[128:131], a[232:235], v[216:219], v[128:131]
    v_mfma_f32_16x16x32_bf16 v[128:131], a[228:231], v[212:215], v[128:131]
    v_mfma_f32_16x16x32_bf16 v[112:115], a[228:231], v[208:211], v[112:115]
    v_mfma_f32_16x16x32_bf16 v[112:115], a[232:235], v[212:215], v[112:115]
    buffer_load_dwordx4 v252, s[12:15], 0 offen offset:1024 lds
    v_mfma_f32_16x16x32_bf16 v[112:115], a[236:239], v[216:219], v[112:115]
    s_add_u32 m0, s75, s4
    v_mfma_f32_16x16x32_bf16 v[96:99], a[236:239], v[212:215], v[96:99]
    v_mfma_f32_16x16x32_bf16 v[96:99], a[232:235], v[208:211], v[96:99]
    v_mfma_f32_16x16x32_bf16 v[96:99], a[228:231], v[204:207], v[96:99]
    v_mfma_f32_16x16x32_bf16 v[80:83], a[228:231], v[200:203], v[80:83]
    v_mfma_f32_16x16x32_bf16 v[80:83], a[232:235], v[204:207], v[80:83]
    buffer_load_dwordx4 v253, s[12:15], 0 offen offset:0 lds
    v_mfma_f32_16x16x32_bf16 v[80:83], a[236:239], v[208:211], v[80:83]
    v_mfma_f32_16x16x32_bf16 v[64:67], a[236:239], v[204:207], v[64:67]
    v_mfma_f32_16x16x32_bf16 v[64:67], a[232:235], v[200:203], v[64:67]
    v_mfma_f32_16x16x32_bf16 v[64:67], a[228:231], v[196:199], v[64:67]
    v_mfma_f32_16x16x32_bf16 v[48:51], a[228:231], v[192:195], v[48:51]
    v_mfma_f32_16x16x32_bf16 v[48:51], a[232:235], v[196:199], v[48:51]
    buffer_load_dwordx4 v253, s[12:15], 0 offen offset:1024 lds
    v_mfma_f32_16x16x32_bf16 v[48:51], a[236:239], v[200:203], v[48:51]
    s_add_u32 m0, s76, s4
    v_mfma_f32_16x16x32_bf16 v[32:35], a[236:239], v[196:199], v[32:35]
    v_mfma_f32_16x16x32_bf16 v[32:35], a[232:235], v[192:195], v[32:35]
    v_mfma_f32_16x16x32_bf16 v[32:35], a[228:231], v[188:191], v[32:35]
    v_mfma_f32_16x16x32_bf16 v[20:23], a[0:3], v[148:151], v[20:23]
    v_mfma_f32_16x16x32_bf16 v[20:23], a[4:7], v[152:155], v[20:23]
    buffer_load_dwordx4 v254, s[12:15], 0 offen offset:0 lds
    v_mfma_f32_16x16x32_bf16 v[20:23], a[8:11], v[156:159], v[20:23]
    v_mfma_f32_16x16x32_bf16 v[36:39], a[8:11], v[160:163], v[36:39]
    v_mfma_f32_16x16x32_bf16 v[36:39], a[4:7], v[156:159], v[36:39]
    v_mfma_f32_16x16x32_bf16 v[36:39], a[0:3], v[152:155], v[36:39]
    v_mfma_f32_16x16x32_bf16 v[52:55], a[0:3], v[156:159], v[52:55]
    v_mfma_f32_16x16x32_bf16 v[52:55], a[4:7], v[160:163], v[52:55]
    buffer_load_dwordx4 v254, s[12:15], 0 offen offset:1024 lds
    v_mfma_f32_16x16x32_bf16 v[52:55], a[8:11], v[164:167], v[52:55]
    s_add_u32 m0, s77, s4
    v_mfma_f32_16x16x32_bf16 v[68:71], a[8:11], v[168:171], v[68:71]
    v_mfma_f32_16x16x32_bf16 v[68:71], a[4:7], v[164:167], v[68:71]
    v_mfma_f32_16x16x32_bf16 v[68:71], a[0:3], v[160:163], v[68:71]
    v_mfma_f32_16x16x32_bf16 v[84:87], a[0:3], v[164:167], v[84:87]
    v_mfma_f32_16x16x32_bf16 v[84:87], a[4:7], v[168:171], v[84:87]
    buffer_load_dwordx4 v255, s[12:15], 0 offen offset:0 lds
    v_mfma_f32_16x16x32_bf16 v[84:87], a[8:11], v[172:175], v[84:87]
    v_mfma_f32_16x16x32_bf16 v[100:103], a[8:11], v[176:179], v[100:103]
    v_mfma_f32_16x16x32_bf16 v[100:103], a[4:7], v[172:175], v[100:103]
    v_mfma_f32_16x16x32_bf16 v[100:103], a[0:3], v[168:171], v[100:103]
    v_mfma_f32_16x16x32_bf16 v[116:119], a[0:3], v[172:175], v[116:119]
    v_mfma_f32_16x16x32_bf16 v[116:119], a[4:7], v[176:179], v[116:119]
    buffer_load_dwordx4 v255, s[12:15], 0 offen offset:1024 lds
    v_mfma_f32_16x16x32_bf16 v[116:119], a[8:11], v[180:183], v[116:119]
    s_add_u32 m0, s71, s7
    s_add_u32 s16, s68, s67
    s_addc_u32 s17, s28, 0
    v_mfma_f32_16x16x32_bf16 v[132:135], a[8:11], v[184:187], v[132:135]
    v_mfma_f32_16x16x32_bf16 v[132:135], a[4:7], v[180:183], v[132:135]
    v_mfma_f32_16x16x32_bf16 v[132:135], a[0:3], v[176:179], v[132:135]
    v_mfma_f32_16x16x32_bf16 v[136:139], a[12:15], v[176:179], v[136:139]
    v_mfma_f32_16x16x32_bf16 v[136:139], a[16:19], v[180:183], v[136:139]
    buffer_load_dwordx4 v10, s[16:19], 0 offen offset:0 lds
    v_mfma_f32_16x16x32_bf16 v[136:139], a[20:23], v[184:187], v[136:139]
    v_mfma_f32_16x16x32_bf16 v[120:123], a[20:23], v[180:183], v[120:123]
    v_mfma_f32_16x16x32_bf16 v[120:123], a[16:19], v[176:179], v[120:123]
    v_mfma_f32_16x16x32_bf16 v[120:123], a[12:15], v[172:175], v[120:123]
    v_mfma_f32_16x16x32_bf16 v[104:107], a[12:15], v[168:171], v[104:107]
    v_mfma_f32_16x16x32_bf16 v[104:107], a[16:19], v[172:175], v[104:107]
    buffer_load_dwordx4 v10, s[16:19], 0 offen offset:1024 lds
    v_mfma_f32_16x16x32_bf16 v[104:107], a[20:23], v[176:179], v[104:107]
    s_add_u32 m0, s72, s7
    s_add_u32 s16, s69, s67
    s_addc_u32 s17, s29, 0
    v_mfma_f32_16x16x32_bf16 v[88:91], a[20:23], v[172:175], v[88:91]
    v_mfma_f32_16x16x32_bf16 v[88:91], a[16:19], v[168:171], v[88:91]
    v_mfma_f32_16x16x32_bf16 v[88:91], a[12:15], v[164:167], v[88:91]
    v_mfma_f32_16x16x32_bf16 v[72:75], a[12:15], v[160:163], v[72:75]
    v_mfma_f32_16x16x32_bf16 v[72:75], a[16:19], v[164:167], v[72:75]
    buffer_load_dwordx4 v10, s[16:19], 0 offen offset:0 lds
    v_mfma_f32_16x16x32_bf16 v[72:75], a[20:23], v[168:171], v[72:75]
    v_mfma_f32_16x16x32_bf16 v[56:59], a[20:23], v[164:167], v[56:59]
    v_mfma_f32_16x16x32_bf16 v[56:59], a[16:19], v[160:163], v[56:59]
    v_mfma_f32_16x16x32_bf16 v[56:59], a[12:15], v[156:159], v[56:59]
    v_mfma_f32_16x16x32_bf16 v[40:43], a[12:15], v[152:155], v[40:43]
    v_mfma_f32_16x16x32_bf16 v[40:43], a[16:19], v[156:159], v[40:43]
    buffer_load_dwordx4 v10, s[16:19], 0 offen offset:1024 lds
    v_mfma_f32_16x16x32_bf16 v[40:43], a[20:23], v[160:163], v[40:43]
    s_add_u32 m0, s73, s7
    s_add_u32 s16, s70, s67
    s_addc_u32 s17, s31, 0
    v_mfma_f32_16x16x32_bf16 v[24:27], a[20:23], v[156:159], v[24:27]
    v_mfma_f32_16x16x32_bf16 v[24:27], a[16:19], v[152:155], v[24:27]
    v_mfma_f32_16x16x32_bf16 v[24:27], a[12:15], v[148:151], v[24:27]
    v_mfma_f32_16x16x32_bf16 v[28:31], a[24:27], v[148:151], v[28:31]
    v_mfma_f32_16x16x32_bf16 v[28:31], a[28:31], v[152:155], v[28:31]
    buffer_load_dwordx4 v10, s[16:19], 0 offen offset:0 lds
    v_mfma_f32_16x16x32_bf16 v[28:31], a[32:35], v[156:159], v[28:31]
    v_mfma_f32_16x16x32_bf16 v[44:47], a[32:35], v[160:163], v[44:47]
    v_mfma_f32_16x16x32_bf16 v[44:47], a[28:31], v[156:159], v[44:47]
    v_mfma_f32_16x16x32_bf16 v[44:47], a[24:27], v[152:155], v[44:47]
    ds_read_b64_tr_b16 a[98:99], v5 offset:512
    v_mfma_f32_16x16x32_bf16 v[60:63], a[24:27], v[156:159], v[60:63]
    ds_read_b64_tr_b16 a[96:97], v5 offset:0
    v_mfma_f32_16x16x32_bf16 v[60:63], a[28:31], v[160:163], v[60:63]
    buffer_load_dwordx4 v10, s[16:19], 0 offen offset:1024 lds
    v_mfma_f32_16x16x32_bf16 v[60:63], a[32:35], v[164:167], v[60:63]
    ds_read_b64_tr_b16 a[102:103], v5 offset:8704
    v_mfma_f32_16x16x32_bf16 v[76:79], a[32:35], v[168:171], v[76:79]
    ds_read_b64_tr_b16 a[100:101], v5 offset:8192
    v_mfma_f32_16x16x32_bf16 v[76:79], a[28:31], v[164:167], v[76:79]
    ds_read_b64_tr_b16 a[106:107], v5 offset:16896
    v_mfma_f32_16x16x32_bf16 v[76:79], a[24:27], v[160:163], v[76:79]
    ds_read_b64_tr_b16 a[104:105], v5 offset:16384
    v_mfma_f32_16x16x32_bf16 v[92:95], a[24:27], v[164:167], v[92:95]
    ds_read_b64_tr_b16 a[118:119], v7 offset:16896
    v_mfma_f32_16x16x32_bf16 v[92:95], a[28:31], v[168:171], v[92:95]
    ds_read_b64_tr_b16 a[116:117], v7 offset:16384
    v_mfma_f32_16x16x32_bf16 v[92:95], a[32:35], v[172:175], v[92:95]
    ds_read_b64_tr_b16 a[114:115], v7 offset:8704
    v_mfma_f32_16x16x32_bf16 v[108:111], a[32:35], v[176:179], v[108:111]
    ds_read_b64_tr_b16 a[112:113], v7 offset:8192
    v_mfma_f32_16x16x32_bf16 v[108:111], a[28:31], v[172:175], v[108:111]
    ds_read_b64_tr_b16 a[110:111], v7 offset:512
    v_mfma_f32_16x16x32_bf16 v[108:111], a[24:27], v[168:171], v[108:111]
    ds_read_b64_tr_b16 a[108:109], v7 offset:0
    v_mfma_f32_16x16x32_bf16 v[124:127], a[24:27], v[172:175], v[124:127]
    ds_read_b64_tr_b16 a[122:123], v5 offset:1536
    v_mfma_f32_16x16x32_bf16 v[124:127], a[28:31], v[176:179], v[124:127]
    ds_read_b64_tr_b16 a[120:121], v5 offset:1024
    v_mfma_f32_16x16x32_bf16 v[124:127], a[32:35], v[180:183], v[124:127]
    ds_read_b64_tr_b16 a[126:127], v5 offset:9728
    v_mfma_f32_16x16x32_bf16 v[140:143], a[32:35], v[184:187], v[140:143]
    ds_read_b64_tr_b16 a[124:125], v5 offset:9216
    v_mfma_f32_16x16x32_bf16 v[140:143], a[28:31], v[180:183], v[140:143]
    ds_read_b64_tr_b16 a[130:131], v5 offset:17920
    v_mfma_f32_16x16x32_bf16 v[140:143], a[24:27], v[176:179], v[140:143]
    s_waitcnt vmcnt(20)
    s_barrier
    v_mfma_f32_16x16x32_bf16 v[144:147], a[36:39], v[176:179], v[144:147]
    ds_read_b64_tr_b16 a[128:129], v5 offset:17408
    v_mfma_f32_16x16x32_bf16 v[144:147], a[40:43], v[180:183], v[144:147]
    ds_read_b64_tr_b16 a[142:143], v7 offset:17920
    v_mfma_f32_16x16x32_bf16 v[144:147], a[44:47], v[184:187], v[144:147]
    ds_read_b64_tr_b16 a[140:141], v7 offset:17408
    v_mfma_f32_16x16x32_bf16 v[128:131], a[44:47], v[180:183], v[128:131]
    ds_read_b64_tr_b16 a[138:139], v7 offset:9728
    v_mfma_f32_16x16x32_bf16 v[128:131], a[40:43], v[176:179], v[128:131]
    ds_read_b64_tr_b16 a[136:137], v7 offset:9216
    v_mfma_f32_16x16x32_bf16 v[128:131], a[36:39], v[172:175], v[128:131]
    ds_read_b64_tr_b16 a[134:135], v7 offset:1536
    v_mfma_f32_16x16x32_bf16 v[112:115], a[36:39], v[168:171], v[112:115]
    ds_read_b64_tr_b16 a[132:133], v7 offset:1024
    v_mfma_f32_16x16x32_bf16 v[112:115], a[40:43], v[172:175], v[112:115]
    ds_read_b128 v[188:191], v1 offset:0
    v_mfma_f32_16x16x32_bf16 v[112:115], a[44:47], v[176:179], v[112:115]
    ds_read_b128 v[192:195], v1 offset:2048
    v_mfma_f32_16x16x32_bf16 v[96:99], a[44:47], v[172:175], v[96:99]
    ds_read_b128 v[196:199], v1 offset:256
    v_mfma_f32_16x16x32_bf16 v[96:99], a[40:43], v[168:171], v[96:99]
    ds_read_b64_tr_b16 a[146:147], v5 offset:25088
    v_mfma_f32_16x16x32_bf16 v[96:99], a[36:39], v[164:167], v[96:99]
    ds_read_b64_tr_b16 a[144:145], v5 offset:24576
    v_mfma_f32_16x16x32_bf16 v[80:83], a[36:39], v[160:163], v[80:83]
    ds_read_b128 v[208:211], v2 offset:0
    v_mfma_f32_16x16x32_bf16 v[80:83], a[40:43], v[164:167], v[80:83]
    ds_read_b64_tr_b16 a[150:151], v5 offset:33280
    v_mfma_f32_16x16x32_bf16 v[80:83], a[44:47], v[168:171], v[80:83]
    ds_read_b64_tr_b16 a[148:149], v5 offset:32768
    v_mfma_f32_16x16x32_bf16 v[64:67], a[44:47], v[164:167], v[64:67]
    ds_read_b128 v[212:215], v2 offset:2048
    v_mfma_f32_16x16x32_bf16 v[64:67], a[40:43], v[160:163], v[64:67]
    ds_read_b64_tr_b16 a[154:155], v5 offset:41472
    v_mfma_f32_16x16x32_bf16 v[64:67], a[36:39], v[156:159], v[64:67]
    ds_read_b64_tr_b16 a[152:153], v5 offset:40960
    v_mfma_f32_16x16x32_bf16 v[48:51], a[36:39], v[152:155], v[48:51]
    ds_read_b128 v[216:219], v2 offset:256
    v_mfma_f32_16x16x32_bf16 v[48:51], a[40:43], v[156:159], v[48:51]
    ds_read_b64_tr_b16 a[166:167], v7 offset:41472
    v_mfma_f32_16x16x32_bf16 v[48:51], a[44:47], v[160:163], v[48:51]
    ds_read_b64_tr_b16 a[164:165], v7 offset:40960
    v_mfma_f32_16x16x32_bf16 v[32:35], a[44:47], v[156:159], v[32:35]
    ds_read_b64_tr_b16 a[162:163], v7 offset:33280
    v_mfma_f32_16x16x32_bf16 v[32:35], a[40:43], v[152:155], v[32:35]
    ds_read_b64_tr_b16 a[160:161], v7 offset:32768
    v_mfma_f32_16x16x32_bf16 v[32:35], a[36:39], v[148:151], v[32:35]
    ds_read_b64_tr_b16 a[158:159], v7 offset:25088
    v_mfma_f32_16x16x32_bf16 v[20:23], a[48:51], v[228:231], v[20:23]
    ds_read_b64_tr_b16 a[156:157], v7 offset:24576
    v_mfma_f32_16x16x32_bf16 v[20:23], a[52:55], v[232:235], v[20:23]
    ds_read_b64_tr_b16 a[170:171], v5 offset:26112
    v_mfma_f32_16x16x32_bf16 v[20:23], a[56:59], v[236:239], v[20:23]
    ds_read_b64_tr_b16 a[168:169], v5 offset:25600
    v_mfma_f32_16x16x32_bf16 v[24:27], a[68:71], v[236:239], v[24:27]
    ds_read_b64_tr_b16 a[174:175], v5 offset:34304
    v_mfma_f32_16x16x32_bf16 v[24:27], a[64:67], v[232:235], v[24:27]
    ds_read_b64_tr_b16 a[172:173], v5 offset:33792
    v_mfma_f32_16x16x32_bf16 v[24:27], a[60:63], v[228:231], v[24:27]
    ds_read_b64_tr_b16 a[178:179], v5 offset:42496
    v_mfma_f32_16x16x32_bf16 v[28:31], a[72:75], v[228:231], v[28:31]
    ds_read_b64_tr_b16 a[176:177], v5 offset:41984
    v_mfma_f32_16x16x32_bf16 v[28:31], a[76:79], v[232:235], v[28:31]
    ds_read_b64_tr_b16 a[190:191], v7 offset:42496
    v_mfma_f32_16x16x32_bf16 v[28:31], a[80:83], v[236:239], v[28:31]
    ds_read_b64_tr_b16 a[188:189], v7 offset:41984
    v_mfma_f32_16x16x32_bf16 v[32:35], a[92:95], v[236:239], v[32:35]
    ds_read_b64_tr_b16 a[186:187], v7 offset:34304
    v_mfma_f32_16x16x32_bf16 v[32:35], a[88:91], v[232:235], v[32:35]
    ds_read_b64_tr_b16 a[184:185], v7 offset:33792
    v_mfma_f32_16x16x32_bf16 v[32:35], a[84:87], v[228:231], v[32:35]
    s_waitcnt lgkmcnt(6)
    ds_read_b64_tr_b16 a[182:183], v7 offset:26112
    v_mfma_f32_16x16x32_bf16 v[20:23], a[96:99], v[188:191], v[20:23]
    s_waitcnt vmcnt(6)
    s_barrier
    v_mfma_f32_16x16x32_bf16 v[20:23], a[100:103], v[192:195], v[20:23]
    ds_read_b64_tr_b16 a[180:181], v7 offset:25600
    v_mfma_f32_16x16x32_bf16 v[20:23], a[104:107], v[196:199], v[20:23]
    ds_read_b64_tr_b16 a[194:195], v6 offset:512
    v_mfma_f32_16x16x32_bf16 v[24:27], a[116:119], v[196:199], v[24:27]
    ds_read_b64_tr_b16 a[192:193], v6 offset:0
    v_mfma_f32_16x16x32_bf16 v[24:27], a[112:115], v[192:195], v[24:27]
    ds_read_b128 v[148:151], v1 offset:32768
    v_mfma_f32_16x16x32_bf16 v[24:27], a[108:111], v[188:191], v[24:27]
    ds_read_b64_tr_b16 a[198:199], v6 offset:8704
    v_mfma_f32_16x16x32_bf16 v[28:31], a[120:123], v[188:191], v[28:31]
    ds_read_b64_tr_b16 a[196:197], v6 offset:8192
    v_mfma_f32_16x16x32_bf16 v[28:31], a[124:127], v[192:195], v[28:31]
    ds_read_b128 v[152:155], v1 offset:34816
    v_mfma_f32_16x16x32_bf16 v[28:31], a[128:131], v[196:199], v[28:31]
    ds_read_b64_tr_b16 a[202:203], v6 offset:16896
    v_mfma_f32_16x16x32_bf16 v[32:35], a[140:143], v[196:199], v[32:35]
    ds_read_b64_tr_b16 a[200:201], v6 offset:16384
    v_mfma_f32_16x16x32_bf16 v[32:35], a[136:139], v[192:195], v[32:35]
    ds_read_b128 v[156:159], v1 offset:33024
    v_mfma_f32_16x16x32_bf16 v[32:35], a[132:135], v[188:191], v[32:35]
    ds_read_b128 v[160:163], v1 offset:35072
    v_mfma_f32_16x16x32_bf16 v[20:23], a[144:147], v[208:211], v[20:23]
    ds_read_b64_tr_b16 a[206:207], v8 offset:512
    v_mfma_f32_16x16x32_bf16 v[20:23], a[148:151], v[212:215], v[20:23]
    ds_read_b64_tr_b16 a[204:205], v8 offset:0
    v_mfma_f32_16x16x32_bf16 v[20:23], a[152:155], v[216:219], v[20:23]
    ds_read_b64_tr_b16 a[210:211], v8 offset:8704
    v_mfma_f32_16x16x32_bf16 v[24:27], a[164:167], v[216:219], v[24:27]
    ds_read_b64_tr_b16 a[208:209], v8 offset:8192
    v_mfma_f32_16x16x32_bf16 v[24:27], a[160:163], v[212:215], v[24:27]
    ds_read_b64_tr_b16 a[214:215], v8 offset:16896
    v_mfma_f32_16x16x32_bf16 v[24:27], a[156:159], v[208:211], v[24:27]
    ds_read_b64_tr_b16 a[212:213], v8 offset:16384
    v_mfma_f32_16x16x32_bf16 v[28:31], a[168:171], v[208:211], v[28:31]
    ds_read_b64_tr_b16 a[218:219], v6 offset:1536
    v_mfma_f32_16x16x32_bf16 v[28:31], a[172:175], v[212:215], v[28:31]
    s_waitcnt lgkmcnt(6)
    ds_read_b64_tr_b16 a[216:217], v6 offset:1024
    v_mfma_f32_16x16x32_bf16 v[28:31], a[176:179], v[216:219], v[28:31]
    ds_read_b64_tr_b16 a[222:223], v6 offset:9728
    v_mfma_f32_16x16x32_bf16 v[32:35], a[188:191], v[216:219], v[32:35]
    ds_read_b64_tr_b16 a[220:221], v6 offset:9216
    v_mfma_f32_16x16x32_bf16 v[32:35], a[184:187], v[212:215], v[32:35]
    ds_read_b64_tr_b16 a[226:227], v6 offset:17920
    v_mfma_f32_16x16x32_bf16 v[32:35], a[180:183], v[208:211], v[32:35]
    ds_read_b64_tr_b16 a[224:225], v6 offset:17408
    v_mfma_f32_16x16x32_bf16 v[20:23], a[192:195], v[148:151], v[20:23]
    ds_read_b64_tr_b16 a[230:231], v8 offset:1536
    v_mfma_f32_16x16x32_bf16 v[20:23], a[196:199], v[152:155], v[20:23]
    ds_read_b64_tr_b16 a[228:229], v8 offset:1024
    v_mfma_f32_16x16x32_bf16 v[20:23], a[200:203], v[156:159], v[20:23]
    ds_read_b64_tr_b16 a[234:235], v8 offset:9728
    v_mfma_f32_16x16x32_bf16 v[36:39], a[200:203], v[160:163], v[36:39]
    ds_read_b64_tr_b16 a[232:233], v8 offset:9216
    v_mfma_f32_16x16x32_bf16 v[36:39], a[196:199], v[156:159], v[36:39]
    ds_read_b64_tr_b16 a[238:239], v8 offset:17920
    v_mfma_f32_16x16x32_bf16 v[36:39], a[192:195], v[152:155], v[36:39]
    s_waitcnt lgkmcnt(6)
    ds_read_b64_tr_b16 a[236:237], v8 offset:17408
    v_mfma_f32_16x16x32_bf16 v[40:43], a[204:207], v[152:155], v[40:43]
    ds_read_b128 v[168:171], v2 offset:32768
    v_mfma_f32_16x16x32_bf16 v[40:43], a[208:211], v[156:159], v[40:43]
    ds_read_b128 v[172:175], v2 offset:34816
    v_mfma_f32_16x16x32_bf16 v[40:43], a[212:215], v[160:163], v[40:43]
    s_waitcnt vmcnt(0)
    s_barrier
    v_mfma_f32_16x16x32_bf16 v[24:27], a[212:215], v[156:159], v[24:27]
    ds_read_b128 v[176:179], v2 offset:33024
    v_mfma_f32_16x16x32_bf16 v[24:27], a[208:211], v[152:155], v[24:27]
    ds_read_b128 v[180:183], v2 offset:35072
    v_mfma_f32_16x16x32_bf16 v[24:27], a[204:207], v[148:151], v[24:27]
    ds_read_b64_tr_b16 a[2:3], v6 offset:25088
    v_mfma_f32_16x16x32_bf16 v[28:31], a[216:219], v[148:151], v[28:31]
    ds_read_b64_tr_b16 a[0:1], v6 offset:24576
    v_mfma_f32_16x16x32_bf16 v[28:31], a[220:223], v[152:155], v[28:31]
    s_waitcnt lgkmcnt(5)
    ds_read_b64_tr_b16 a[6:7], v6 offset:33280
    v_mfma_f32_16x16x32_bf16 v[28:31], a[224:227], v[156:159], v[28:31]
    ds_read_b64_tr_b16 a[4:5], v6 offset:32768
    v_mfma_f32_16x16x32_bf16 v[44:47], a[224:227], v[160:163], v[44:47]
    ds_read_b64_tr_b16 a[10:11], v6 offset:41472
    v_mfma_f32_16x16x32_bf16 v[44:47], a[220:223], v[156:159], v[44:47]
    ds_read_b64_tr_b16 a[8:9], v6 offset:40960
    v_mfma_f32_16x16x32_bf16 v[44:47], a[216:219], v[152:155], v[44:47]
    ds_read_b64_tr_b16 a[14:15], v8 offset:25088
    v_mfma_f32_16x16x32_bf16 v[48:51], a[228:231], v[152:155], v[48:51]
    ds_read_b64_tr_b16 a[12:13], v8 offset:24576
    v_mfma_f32_16x16x32_bf16 v[48:51], a[232:235], v[156:159], v[48:51]
    ds_read_b64_tr_b16 a[18:19], v8 offset:33280
    v_mfma_f32_16x16x32_bf16 v[48:51], a[236:239], v[160:163], v[48:51]
    ds_read_b64_tr_b16 a[16:17], v8 offset:32768
    v_mfma_f32_16x16x32_bf16 v[32:35], a[236:239], v[156:159], v[32:35]
    ds_read_b64_tr_b16 a[22:23], v8 offset:41472
    v_mfma_f32_16x16x32_bf16 v[32:35], a[232:235], v[152:155], v[32:35]
    ds_read_b64_tr_b16 a[20:21], v8 offset:40960
    v_mfma_f32_16x16x32_bf16 v[32:35], a[228:231], v[148:151], v[32:35]
    s_waitcnt lgkmcnt(6)
    ds_read_b64_tr_b16 a[26:27], v6 offset:26112
    v_mfma_f32_16x16x32_bf16 v[20:23], a[0:3], v[168:171], v[20:23]
    ds_read_b64_tr_b16 a[24:25], v6 offset:25600
    v_mfma_f32_16x16x32_bf16 v[20:23], a[4:7], v[172:175], v[20:23]
    ds_read_b64_tr_b16 a[30:31], v6 offset:34304
    v_mfma_f32_16x16x32_bf16 v[20:23], a[8:11], v[176:179], v[20:23]
    ds_read_b64_tr_b16 a[28:29], v6 offset:33792
    v_mfma_f32_16x16x32_bf16 v[36:39], a[8:11], v[180:183], v[36:39]
    ds_read_b64_tr_b16 a[34:35], v6 offset:42496
    v_mfma_f32_16x16x32_bf16 v[36:39], a[4:7], v[176:179], v[36:39]
    ds_read_b64_tr_b16 a[32:33], v6 offset:41984
    v_mfma_f32_16x16x32_bf16 v[36:39], a[0:3], v[172:175], v[36:39]
    s_waitcnt lgkmcnt(6)
    ds_read_b64_tr_b16 a[38:39], v8 offset:26112
    v_fma_f32 v20, v20, s38, -v18
    v_mfma_f32_16x16x32_bf16 v[40:43], a[12:15], v[172:175], v[40:43]
    ds_read_b64_tr_b16 a[36:37], v8 offset:25600
    v_med3_f32 v20, v20, -s33, s33
    v_mfma_f32_16x16x32_bf16 v[40:43], a[16:19], v[176:179], v[40:43]
    ds_read_b64_tr_b16 a[42:43], v8 offset:34304
    v_fma_f32 v21, v21, s38, -v18
    v_mfma_f32_16x16x32_bf16 v[40:43], a[20:23], v[180:183], v[40:43]
    ds_read_b64_tr_b16 a[40:41], v8 offset:33792
    v_med3_f32 v21, v21, -s33, s33
    v_mfma_f32_16x16x32_bf16 v[24:27], a[20:23], v[176:179], v[24:27]
    ds_read_b64_tr_b16 a[46:47], v8 offset:42496
    v_fma_f32 v22, v22, s38, -v18
    v_mfma_f32_16x16x32_bf16 v[24:27], a[16:19], v[172:175], v[24:27]
    ds_read_b64_tr_b16 a[44:45], v8 offset:41984
    v_med3_f32 v22, v22, -s33, s33
    v_mfma_f32_16x16x32_bf16 v[24:27], a[12:15], v[168:171], v[24:27]
    s_waitcnt lgkmcnt(6)
    v_exp_f32 v20, v20
    v_mfma_f32_16x16x32_bf16 v[28:31], a[24:27], v[168:171], v[28:31]
    v_exp_f32 v21, v21
    v_mfma_f32_16x16x32_bf16 v[28:31], a[28:31], v[172:175], v[28:31]
    v_exp_f32 v22, v22
    v_mfma_f32_16x16x32_bf16 v[28:31], a[32:35], v[176:179], v[28:31]
    v_fma_f32 v23, v23, s38, -v18
    v_fma_f32 v24, v24, s38, -v18
    v_mfma_f32_16x16x32_bf16 v[44:47], a[32:35], v[180:183], v[44:47]
    v_med3_f32 v23, v23, -s33, s33
    v_med3_f32 v24, v24, -s33, s33
    v_mfma_f32_16x16x32_bf16 v[44:47], a[28:31], v[176:179], v[44:47]
    v_exp_f32 v23, v23
    v_mfma_f32_16x16x32_bf16 v[44:47], a[24:27], v[172:175], v[44:47]
    s_waitcnt lgkmcnt(0)
    v_fma_f32 v28, v28, s48, v19
    v_fma_f32 v29, v29, s48, v19
    v_mfma_f32_16x16x32_bf16 v[48:51], a[36:39], v[172:175], v[48:51]
    v_exp_f32 v28, v28
    v_mfma_f32_16x16x32_bf16 v[48:51], a[40:43], v[176:179], v[48:51]
    ds_read_b128 v[200:203], v1 offset:2304
    v_add_f32 v28, 1.0, v28
    v_mfma_f32_16x16x32_bf16 v[48:51], a[44:47], v[180:183], v[48:51]
    v_fmac_f32 v28, v20, v28
    v_fma_f32 v30, v30, s48, v19
    v_mfma_f32_16x16x32_bf16 v[32:35], a[44:47], v[176:179], v[32:35]
    v_rcp_f32 v28, v28
    v_mfma_f32_16x16x32_bf16 v[32:35], a[40:43], v[172:175], v[32:35]
    ds_read_b128 v[220:223], v2 offset:2304
    v_fma_f32 v28, -v20, v28, v28
    v_mfma_f32_16x16x32_bf16 v[32:35], a[36:39], v[168:171], v[32:35]
    v_fma_f32 v31, v31, s48, v19
    v_fma_f32 v25, v25, s38, -v18
    v_mfma_f32_16x16x32_bf16 v[36:39], a[48:51], v[232:235], v[36:39]
    v_exp_f32 v29, v29
    v_mfma_f32_16x16x32_bf16 v[36:39], a[52:55], v[236:239], v[36:39]
    v_add_f32 v29, 1.0, v29
    v_med3_f32 v25, v25, -s33, s33
    v_mfma_f32_16x16x32_bf16 v[36:39], a[56:59], v[240:243], v[36:39]
    v_exp_f32 v30, v30
    v_mfma_f32_16x16x32_bf16 v[36:39], a[96:99], v[192:195], v[36:39]
    v_fmac_f32 v29, v21, v29
    v_add_f32 v30, 1.0, v30
    v_mfma_f32_16x16x32_bf16 v[36:39], a[100:103], v[196:199], v[36:39]
    s_waitcnt lgkmcnt(1)
    v_rcp_f32 v29, v29
    v_mfma_f32_16x16x32_bf16 v[36:39], a[104:107], v[200:203], v[36:39]
    v_fma_f32 v29, -v21, v29, v29
    v_fmac_f32 v30, v22, v30
    v_mfma_f32_16x16x32_bf16 v[36:39], a[144:147], v[212:215], v[36:39]
    v_rcp_f32 v30, v30
    v_mfma_f32_16x16x32_bf16 v[36:39], a[148:151], v[216:219], v[36:39]
    s_waitcnt lgkmcnt(0)
    v_fma_f32 v30, -v22, v30, v30
    v_fma_f32 v32, v32, s48, v19
    v_mfma_f32_16x16x32_bf16 v[36:39], a[152:155], v[220:223], v[36:39]
    v_exp_f32 v31, v31
    v_mfma_f32_16x16x32_bf16 v[44:47], a[176:179], v[220:223], v[44:47]
    v_add_f32 v31, 1.0, v31
    v_fma_f32 v33, v33, s48, v19
    v_mfma_f32_16x16x32_bf16 v[44:47], a[172:175], v[216:219], v[44:47]
    v_exp_f32 v24, v24
    v_mfma_f32_16x16x32_bf16 v[44:47], a[168:171], v[212:215], v[44:47]
    v_fmac_f32 v31, v23, v31
    v_fma_f32 v26, v26, s38, -v18
    v_mfma_f32_16x16x32_bf16 v[44:47], a[128:131], v[200:203], v[44:47]
    v_rcp_f32 v31, v31
    v_mfma_f32_16x16x32_bf16 v[44:47], a[124:127], v[196:199], v[44:47]
    v_fma_f32 v31, -v23, v31, v31
    v_med3_f32 v26, v26, -s33, s33
    v_mfma_f32_16x16x32_bf16 v[44:47], a[120:123], v[192:195], v[44:47]
    v_exp_f32 v32, v32
    v_mfma_f32_16x16x32_bf16 v[44:47], a[80:83], v[240:243], v[44:47]
    v_add_f32 v32, 1.0, v32
    v_fma_f32 v34, v34, s48, v19
    v_mfma_f32_16x16x32_bf16 v[44:47], a[76:79], v[236:239], v[44:47]
    v_exp_f32 v25, v25
    v_mfma_f32_16x16x32_bf16 v[44:47], a[72:75], v[232:235], v[44:47]
    v_fmac_f32 v32, v24, v32
    v_fma_f32 v27, v27, s38, -v18
    v_mfma_f32_16x16x32_bf16 v[40:43], a[60:63], v[232:235], v[40:43]
    v_rcp_f32 v32, v32
    v_mfma_f32_16x16x32_bf16 v[40:43], a[64:67], v[236:239], v[40:43]
    v_fma_f32 v32, -v24, v32, v32
    v_med3_f32 v27, v27, -s33, s33
    v_mfma_f32_16x16x32_bf16 v[40:43], a[68:71], v[240:243], v[40:43]
    v_exp_f32 v33, v33
    v_mfma_f32_16x16x32_bf16 v[40:43], a[108:111], v[192:195], v[40:43]
    v_add_f32 v33, 1.0, v33
    v_fma_f32 v35, v35, s48, v19
    v_mfma_f32_16x16x32_bf16 v[40:43], a[112:115], v[196:199], v[40:43]
    v_exp_f32 v26, v26
    v_mfma_f32_16x16x32_bf16 v[40:43], a[116:119], v[200:203], v[40:43]
    v_fmac_f32 v33, v25, v33
    v_cvt_pk_bf16_f32 v20, v28, v29
    v_mfma_f32_16x16x32_bf16 v[40:43], a[156:159], v[212:215], v[40:43]
    v_rcp_f32 v33, v33
    v_mfma_f32_16x16x32_bf16 v[40:43], a[160:163], v[216:219], v[40:43]
    v_fma_f32 v33, -v25, v33, v33
    v_cvt_pk_bf16_f32 v21, v30, v31
    v_mfma_f32_16x16x32_bf16 v[40:43], a[164:167], v[220:223], v[40:43]
    v_exp_f32 v34, v34
    v_mfma_f32_16x16x32_bf16 v[48:51], a[188:191], v[220:223], v[48:51]
    v_add_f32 v34, 1.0, v34
    v_cvt_pk_bf16_f32 v22, v32, v33
    v_mfma_f32_16x16x32_bf16 v[48:51], a[184:187], v[216:219], v[48:51]
    v_exp_f32 v27, v27
    v_mfma_f32_16x16x32_bf16 v[48:51], a[180:183], v[212:215], v[48:51]
    v_fmac_f32 v34, v26, v34
    v_fma_f32 v36, v36, s38, -v18
    v_mfma_f32_16x16x32_bf16 v[48:51], a[140:143], v[200:203], v[48:51]
    v_rcp_f32 v34, v34
    v_mfma_f32_16x16x32_bf16 v[48:51], a[136:139], v[196:199], v[48:51]
    ds_read_b128 v[204:207], v1 offset:512
    v_fma_f32 v34, -v26, v34, v34
    v_mfma_f32_16x16x32_bf16 v[48:51], a[132:135], v[192:195], v[48:51]
    v_exp_f32 v35, v35
    v_mfma_f32_16x16x32_bf16 v[48:51], a[92:95], v[240:243], v[48:51]
    v_add_f32 v35, 1.0, v35
    v_med3_f32 v36, v36, -s33, s33
    v_mfma_f32_16x16x32_bf16 v[48:51], a[88:91], v[236:239], v[48:51]
    ds_read_b128 v[224:227], v2 offset:512
    v_fmac_f32 v35, v27, v35
    v_mfma_f32_16x16x32_bf16 v[48:51], a[84:87], v[232:235], v[48:51]
    v_rcp_f32 v35, v35
    v_mfma_f32_16x16x32_bf16 v[52:55], a[48:51], v[236:239], v[52:55]
    v_fma_f32 v35, -v27, v35, v35
    v_fma_f32 v44, v44, s48, v19
    v_mfma_f32_16x16x32_bf16 v[52:55], a[52:55], v[240:243], v[52:55]
L_pg3:
    s_cmp_eq_u32 s30, 1
    s_cbranch_scc1 L_warm_ret
    ds_read_b128 v[164:167], v1 offset:33280
    v_cvt_pk_bf16_f32 v23, v34, v35
    v_mfma_f32_16x16x32_bf16 v[52:55], a[56:59], v[244:247], v[52:55]
    v_permlane16_swap_b32 v20, v22
    v_mfma_f32_16x16x32_bf16 v[52:55], a[96:99], v[196:199], v[52:55]
    v_permlane16_swap_b32 v21, v23
    v_mfma_f32_16x16x32_bf16 v[52:55], a[100:103], v[200:203], v[52:55]
    s_waitcnt lgkmcnt(2)
    ds_read_b128 v[184:187], v2 offset:33280
    v_fma_f32 v37, v37, s38, -v18
    v_mfma_f32_16x16x32_bf16 v[52:55], a[104:107], v[204:207], v[52:55]
    buffer_store_dwordx4 v[20:23], v9, s[20:23], 0 offen offset:0 sc1
    v_med3_f32 v37, v37, -s33, s33
    v_mfma_f32_16x16x32_bf16 v[52:55], a[144:147], v[216:219], v[52:55]
    v_fma_f32 v45, v45, s48, v19
    v_fma_f32 v38, v38, s38, -v18
    v_mfma_f32_16x16x32_bf16 v[52:55], a[148:151], v[220:223], v[52:55]
    s_waitcnt lgkmcnt(2)
    v_exp_f32 v36, v36
    v_mfma_f32_16x16x32_bf16 v[52:55], a[152:155], v[224:227], v[52:55]
    v_med3_f32 v38, v38, -s33, s33
    v_fma_f32 v46, v46, s48, v19
    v_mfma_f32_16x16x32_bf16 v[52:55], a[192:195], v[156:159], v[52:55]
    v_exp_f32 v44, v44
    v_mfma_f32_16x16x32_bf16 v[52:55], a[196:199], v[160:163], v[52:55]
    s_waitcnt lgkmcnt(1)
    v_add_f32 v44, 1.0, v44
    v_fma_f32 v39, v39, s38, -v18
    v_mfma_f32_16x16x32_bf16 v[52:55], a[200:203], v[164:167], v[52:55]
    v_exp_f32 v37, v37
    v_mfma_f32_16x16x32_bf16 v[52:55], a[0:3], v[176:179], v[52:55]
    v_fmac_f32 v44, v36, v44
    v_med3_f32 v39, v39, -s33, s33
    v_mfma_f32_16x16x32_bf16 v[52:55], a[4:7], v[180:183], v[52:55]
    s_waitcnt lgkmcnt(0)
    v_rcp_f32 v44, v44
    v_mfma_f32_16x16x32_bf16 v[52:55], a[8:11], v[184:187], v[52:55]
    v_fma_f32 v44, -v36, v44, v44
    v_fma_f32 v47, v47, s48, v19
    v_mfma_f32_16x16x32_bf16 v[60:63], a[32:35], v[184:187], v[60:63]
    v_exp_f32 v45, v45
    v_mfma_f32_16x16x32_bf16 v[60:63], a[28:31], v[180:183], v[60:63]
    v_add_f32 v45, 1.0, v45
    v_fma_f32 v40, v40, s38, -v18
    v_mfma_f32_16x16x32_bf16 v[60:63], a[24:27], v[176:179], v[60:63]
    v_exp_f32 v38, v38
    v_mfma_f32_16x16x32_bf16 v[60:63], a[224:227], v[164:167], v[60:63]
    v_fmac_f32 v45, v37, v45
    v_med3_f32 v40, v40, -s33, s33
    v_mfma_f32_16x16x32_bf16 v[60:63], a[220:223], v[160:163], v[60:63]
    v_rcp_f32 v45, v45
    v_mfma_f32_16x16x32_bf16 v[60:63], a[216:219], v[156:159], v[60:63]
    v_fma_f32 v45, -v37, v45, v45
    v_fma_f32 v48, v48, s48, v19
    v_mfma_f32_16x16x32_bf16 v[60:63], a[176:179], v[224:227], v[60:63]
    v_exp_f32 v46, v46
    v_mfma_f32_16x16x32_bf16 v[60:63], a[172:175], v[220:223], v[60:63]
    v_add_f32 v46, 1.0, v46
    v_fma_f32 v41, v41, s38, -v18
    v_mfma_f32_16x16x32_bf16 v[60:63], a[168:171], v[216:219], v[60:63]
    v_exp_f32 v39, v39
    v_mfma_f32_16x16x32_bf16 v[60:63], a[128:131], v[204:207], v[60:63]
    v_fmac_f32 v46, v38, v46
    v_med3_f32 v41, v41, -s33, s33
    v_mfma_f32_16x16x32_bf16 v[60:63], a[124:127], v[200:203], v[60:63]
    v_rcp_f32 v46, v46
    v_mfma_f32_16x16x32_bf16 v[60:63], a[120:123], v[196:199], v[60:63]
    v_fma_f32 v46, -v38, v46, v46
    v_fma_f32 v49, v49, s48, v19
    v_mfma_f32_16x16x32_bf16 v[60:63], a[80:83], v[244:247], v[60:63]
    v_exp_f32 v47, v47
    v_mfma_f32_16x16x32_bf16 v[60:63], a[76:79], v[240:243], v[60:63]
    v_add_f32 v47, 1.0, v47
    v_fma_f32 v42, v42, s38, -v18
    v_mfma_f32_16x16x32_bf16 v[60:63], a[72:75], v[236:239], v[60:63]
    v_exp_f32 v40, v40
    v_mfma_f32_16x16x32_bf16 v[56:59], a[60:63], v[236:239], v[56:59]
    v_fmac_f32 v47, v39, v47
    v_med3_f32 v42, v42, -s33, s33
    v_mfma_f32_16x16x32_bf16 v[56:59], a[64:67], v[240:243], v[56:59]
    v_rcp_f32 v47, v47
    v_mfma_f32_16x16x32_bf16 v[56:59], a[68:71], v[244:247], v[56:59]
    v_fma_f32 v47, -v39, v47, v47
    v_fma_f32 v50, v50, s48, v19
    v_mfma_f32_16x16x32_bf16 v[56:59], a[108:111], v[196:199], v[56:59]
    v_exp_f32 v48, v48
    v_mfma_f32_16x16x32_bf16 v[56:59], a[112:115], v[200:203], v[56:59]
    v_add_f32 v48, 1.0, v48
    v_fma_f32 v43, v43, s38, -v18
    v_mfma_f32_16x16x32_bf16 v[56:59], a[116:119], v[204:207], v[56:59]
    v_exp_f32 v41, v41
    v_mfma_f32_16x16x32_bf16 v[56:59], a[156:159], v[216:219], v[56:59]
    v_fmac_f32 v48, v40, v48
    v_med3_f32 v43, v43, -s33, s33
    v_mfma_f32_16x16x32_bf16 v[56:59], a[160:163], v[220:223], v[56:59]
    v_rcp_f32 v48, v48
    v_mfma_f32_16x16x32_bf16 v[56:59], a[164:167], v[224:227], v[56:59]
    v_fma_f32 v48, -v40, v48, v48
    v_fma_f32 v51, v51, s48, v19
    v_mfma_f32_16x16x32_bf16 v[56:59], a[204:207], v[156:159], v[56:59]
    v_exp_f32 v49, v49
    v_mfma_f32_16x16x32_bf16 v[56:59], a[208:211], v[160:163], v[56:59]
    v_add_f32 v49, 1.0, v49
    v_cvt_pk_bf16_f32 v36, v44, v45
    v_mfma_f32_16x16x32_bf16 v[56:59], a[212:215], v[164:167], v[56:59]
    v_exp_f32 v42, v42
    v_mfma_f32_16x16x32_bf16 v[56:59], a[12:15], v[176:179], v[56:59]
    v_fmac_f32 v49, v41, v49
    v_cvt_pk_bf16_f32 v37, v46, v47
    v_mfma_f32_16x16x32_bf16 v[56:59], a[16:19], v[180:183], v[56:59]
    v_rcp_f32 v49, v49
    v_mfma_f32_16x16x32_bf16 v[56:59], a[20:23], v[184:187], v[56:59]
    v_fma_f32 v49, -v41, v49, v49
    v_fma_f32 v52, v52, s38, -v18
    v_mfma_f32_16x16x32_bf16 v[64:67], a[44:47], v[184:187], v[64:67]
    v_exp_f32 v50, v50
    v_mfma_f32_16x16x32_bf16 v[64:67], a[40:43], v[180:183], v[64:67]
    v_add_f32 v50, 1.0, v50
    v_cvt_pk_bf16_f32 v38, v48, v49
    v_mfma_f32_16x16x32_bf16 v[64:67], a[36:39], v[176:179], v[64:67]
    v_exp_f32 v43, v43
    v_mfma_f32_16x16x32_bf16 v[64:67], a[236:239], v[164:167], v[64:67]
    v_fmac_f32 v50, v42, v50
    v_med3_f32 v52, v52, -s33, s33
    v_mfma_f32_16x16x32_bf16 v[64:67], a[232:235], v[160:163], v[64:67]
    v_rcp_f32 v50, v50
    v_mfma_f32_16x16x32_bf16 v[64:67], a[228:231], v[156:159], v[64:67]
    v_fma_f32 v50, -v42, v50, v50
    v_fma_f32 v60, v60, s48, v19
    v_mfma_f32_16x16x32_bf16 v[64:67], a[188:191], v[224:227], v[64:67]
    v_exp_f32 v51, v51
    v_mfma_f32_16x16x32_bf16 v[64:67], a[184:187], v[220:223], v[64:67]
    v_add_f32 v51, 1.0, v51
    v_fma_f32 v53, v53, s38, -v18
    v_mfma_f32_16x16x32_bf16 v[64:67], a[180:183], v[216:219], v[64:67]
    v_permlane16_swap_b32 v36, v38
    v_mfma_f32_16x16x32_bf16 v[64:67], a[140:143], v[204:207], v[64:67]
    v_fmac_f32 v51, v43, v51
    v_med3_f32 v53, v53, -s33, s33
    v_mfma_f32_16x16x32_bf16 v[64:67], a[136:139], v[200:203], v[64:67]
    ds_read_b128 v[188:191], v1 offset:2560
    v_fma_f32 v61, v61, s48, v19
    v_mfma_f32_16x16x32_bf16 v[64:67], a[132:135], v[196:199], v[64:67]
    v_rcp_f32 v51, v51
    v_mfma_f32_16x16x32_bf16 v[64:67], a[92:95], v[244:247], v[64:67]
    v_fma_f32 v51, -v43, v51, v51
    v_fma_f32 v54, v54, s38, -v18
    v_mfma_f32_16x16x32_bf16 v[64:67], a[88:91], v[240:243], v[64:67]
    ds_read_b128 v[208:211], v2 offset:2560
    v_cvt_pk_bf16_f32 v39, v50, v51
    v_mfma_f32_16x16x32_bf16 v[64:67], a[84:87], v[236:239], v[64:67]
    v_exp_f32 v52, v52
    v_mfma_f32_16x16x32_bf16 v[68:71], a[48:51], v[240:243], v[68:71]
    v_permlane16_swap_b32 v37, v39
    v_mfma_f32_16x16x32_bf16 v[68:71], a[52:55], v[244:247], v[68:71]
    ds_read_b128 v[148:151], v1 offset:35328
    v_med3_f32 v54, v54, -s33, s33
    v_mfma_f32_16x16x32_bf16 v[68:71], a[56:59], v[248:251], v[68:71]
    buffer_store_dwordx4 v[36:39], v9, s[20:23], 0 offen offset:2048 sc1
    v_fma_f32 v62, v62, s48, v19
    v_mfma_f32_16x16x32_bf16 v[68:71], a[96:99], v[200:203], v[68:71]
    v_fma_f32 v55, v55, s38, -v18
    v_fma_f32 v63, v63, s48, v19
    v_mfma_f32_16x16x32_bf16 v[68:71], a[100:103], v[204:207], v[68:71]
    s_waitcnt lgkmcnt(2)
    ds_read_b128 v[168:171], v2 offset:35328
    v_med3_f32 v55, v55, -s33, s33
    v_mfma_f32_16x16x32_bf16 v[68:71], a[104:107], v[188:191], v[68:71]
    v_exp_f32 v60, v60
    v_mfma_f32_16x16x32_bf16 v[68:71], a[144:147], v[220:223], v[68:71]
    v_add_f32 v60, 1.0, v60
    v_fma_f32 v56, v56, s38, -v18
    v_mfma_f32_16x16x32_bf16 v[68:71], a[148:151], v[224:227], v[68:71]
    s_waitcnt lgkmcnt(2)
    v_exp_f32 v53, v53
    v_mfma_f32_16x16x32_bf16 v[68:71], a[152:155], v[208:211], v[68:71]
    v_fmac_f32 v60, v52, v60
    v_med3_f32 v56, v56, -s33, s33
    v_mfma_f32_16x16x32_bf16 v[68:71], a[192:195], v[160:163], v[68:71]
    v_rcp_f32 v60, v60
    v_mfma_f32_16x16x32_bf16 v[68:71], a[196:199], v[164:167], v[68:71]
    s_waitcnt lgkmcnt(1)
    v_fma_f32 v60, -v52, v60, v60
    v_fma_f32 v64, v64, s48, v19
    v_mfma_f32_16x16x32_bf16 v[68:71], a[200:203], v[148:151], v[68:71]
    v_exp_f32 v61, v61
    v_mfma_f32_16x16x32_bf16 v[68:71], a[0:3], v[180:183], v[68:71]
    v_add_f32 v61, 1.0, v61
    v_fma_f32 v57, v57, s38, -v18
    v_mfma_f32_16x16x32_bf16 v[68:71], a[4:7], v[184:187], v[68:71]
    s_waitcnt lgkmcnt(0)
    v_exp_f32 v54, v54
    v_mfma_f32_16x16x32_bf16 v[68:71], a[8:11], v[168:171], v[68:71]
    v_fmac_f32 v61, v53, v61
    v_med3_f32 v57, v57, -s33, s33
    v_mfma_f32_16x16x32_bf16 v[76:79], a[32:35], v[168:171], v[76:79]
    v_rcp_f32 v61, v61
    v_mfma_f32_16x16x32_bf16 v[76:79], a[28:31], v[184:187], v[76:79]
    v_fma_f32 v61, -v53, v61, v61
    v_fma_f32 v65, v65, s48, v19
    v_mfma_f32_16x16x32_bf16 v[76:79], a[24:27], v[180:183], v[76:79]
    v_exp_f32 v62, v62
    v_mfma_f32_16x16x32_bf16 v[76:79], a[224:227], v[148:151], v[76:79]
    v_add_f32 v62, 1.0, v62
    v_fma_f32 v58, v58, s38, -v18
    v_mfma_f32_16x16x32_bf16 v[76:79], a[220:223], v[164:167], v[76:79]
    v_exp_f32 v55, v55
    v_mfma_f32_16x16x32_bf16 v[76:79], a[216:219], v[160:163], v[76:79]
    v_fmac_f32 v62, v54, v62
    v_med3_f32 v58, v58, -s33, s33
    v_mfma_f32_16x16x32_bf16 v[76:79], a[176:179], v[208:211], v[76:79]
    v_rcp_f32 v62, v62
    v_mfma_f32_16x16x32_bf16 v[76:79], a[172:175], v[224:227], v[76:79]
    v_fma_f32 v62, -v54, v62, v62
    v_fma_f32 v66, v66, s48, v19
    v_mfma_f32_16x16x32_bf16 v[76:79], a[168:171], v[220:223], v[76:79]
    v_exp_f32 v63, v63
    v_mfma_f32_16x16x32_bf16 v[76:79], a[128:131], v[188:191], v[76:79]
    v_add_f32 v63, 1.0, v63
    v_fma_f32 v59, v59, s38, -v18
    v_mfma_f32_16x16x32_bf16 v[76:79], a[124:127], v[204:207], v[76:79]
    v_exp_f32 v56, v56
    v_mfma_f32_16x16x32_bf16 v[76:79], a[120:123], v[200:203], v[76:79]
    v_fmac_f32 v63, v55, v63
    v_med3_f32 v59, v59, -s33, s33
    v_mfma_f32_16x16x32_bf16 v[76:79], a[80:83], v[248:251], v[76:79]
    v_rcp_f32 v63, v63
    v_mfma_f32_16x16x32_bf16 v[76:79], a[76:79], v[244:247], v[76:79]
    v_fma_f32 v63, -v55, v63, v63
    v_fma_f32 v67, v67, s48, v19
    v_mfma_f32_16x16x32_bf16 v[76:79], a[72:75], v[240:243], v[76:79]
    v_exp_f32 v64, v64
    v_mfma_f32_16x16x32_bf16 v[72:75], a[60:63], v[240:243], v[72:75]
    v_add_f32 v64, 1.0, v64
    v_cvt_pk_bf16_f32 v52, v60, v61
    v_mfma_f32_16x16x32_bf16 v[72:75], a[64:67], v[244:247], v[72:75]
    v_exp_f32 v57, v57
    v_mfma_f32_16x16x32_bf16 v[72:75], a[68:71], v[248:251], v[72:75]
    v_fmac_f32 v64, v56, v64
    v_cvt_pk_bf16_f32 v53, v62, v63
    v_mfma_f32_16x16x32_bf16 v[72:75], a[108:111], v[200:203], v[72:75]
    v_rcp_f32 v64, v64
    v_mfma_f32_16x16x32_bf16 v[72:75], a[112:115], v[204:207], v[72:75]
    v_fma_f32 v64, -v56, v64, v64
    v_fma_f32 v68, v68, s38, -v18
    v_mfma_f32_16x16x32_bf16 v[72:75], a[116:119], v[188:191], v[72:75]
    v_exp_f32 v65, v65
    v_mfma_f32_16x16x32_bf16 v[72:75], a[156:159], v[220:223], v[72:75]
    v_add_f32 v65, 1.0, v65
    v_med3_f32 v68, v68, -s33, s33
    v_mfma_f32_16x16x32_bf16 v[72:75], a[160:163], v[224:227], v[72:75]
    v_exp_f32 v58, v58
    v_mfma_f32_16x16x32_bf16 v[72:75], a[164:167], v[208:211], v[72:75]
    v_fmac_f32 v65, v57, v65
    v_fma_f32 v76, v76, s48, v19
    v_mfma_f32_16x16x32_bf16 v[72:75], a[204:207], v[160:163], v[72:75]
    v_rcp_f32 v65, v65
    v_mfma_f32_16x16x32_bf16 v[72:75], a[208:211], v[164:167], v[72:75]
    v_fma_f32 v65, -v57, v65, v65
    v_fma_f32 v69, v69, s38, -v18
    v_mfma_f32_16x16x32_bf16 v[72:75], a[212:215], v[148:151], v[72:75]
    v_exp_f32 v66, v66
    v_mfma_f32_16x16x32_bf16 v[72:75], a[12:15], v[180:183], v[72:75]
    v_add_f32 v66, 1.0, v66
    v_cvt_pk_bf16_f32 v54, v64, v65
    v_mfma_f32_16x16x32_bf16 v[72:75], a[16:19], v[184:187], v[72:75]
    v_exp_f32 v59, v59
    v_mfma_f32_16x16x32_bf16 v[72:75], a[20:23], v[168:171], v[72:75]
    v_fmac_f32 v66, v58, v66
    v_med3_f32 v69, v69, -s33, s33
    v_mfma_f32_16x16x32_bf16 v[80:83], a[44:47], v[168:171], v[80:83]
    v_rcp_f32 v66, v66
    v_mfma_f32_16x16x32_bf16 v[80:83], a[40:43], v[184:187], v[80:83]
    v_fma_f32 v66, -v58, v66, v66
    v_fma_f32 v77, v77, s48, v19
    v_mfma_f32_16x16x32_bf16 v[80:83], a[36:39], v[180:183], v[80:83]
    v_exp_f32 v67, v67
    v_mfma_f32_16x16x32_bf16 v[80:83], a[236:239], v[148:151], v[80:83]
    v_add_f32 v67, 1.0, v67
    v_fma_f32 v70, v70, s38, -v18
    v_mfma_f32_16x16x32_bf16 v[80:83], a[232:235], v[164:167], v[80:83]
    v_permlane16_swap_b32 v52, v54
    v_mfma_f32_16x16x32_bf16 v[80:83], a[228:231], v[160:163], v[80:83]
    v_fmac_f32 v67, v59, v67
    v_med3_f32 v70, v70, -s33, s33
    v_mfma_f32_16x16x32_bf16 v[80:83], a[188:191], v[208:211], v[80:83]
    v_rcp_f32 v67, v67
    v_mfma_f32_16x16x32_bf16 v[80:83], a[184:187], v[224:227], v[80:83]
    v_fma_f32 v67, -v59, v67, v67
    v_fma_f32 v78, v78, s48, v19
    v_mfma_f32_16x16x32_bf16 v[80:83], a[180:183], v[220:223], v[80:83]
    v_cvt_pk_bf16_f32 v55, v66, v67
    v_fma_f32 v71, v71, s38, -v18
    v_mfma_f32_16x16x32_bf16 v[80:83], a[140:143], v[188:191], v[80:83]
    v_permlane16_swap_b32 v53, v55
    v_mfma_f32_16x16x32_bf16 v[80:83], a[136:139], v[204:207], v[80:83]
    ds_read_b128 v[192:195], v1 offset:768
    v_med3_f32 v71, v71, -s33, s33
    v_mfma_f32_16x16x32_bf16 v[80:83], a[132:135], v[200:203], v[80:83]
    buffer_store_dwordx4 v[52:55], v12, s[20:23], 0 offen offset:0 sc1
    v_fma_f32 v79, v79, s48, v19
    v_mfma_f32_16x16x32_bf16 v[80:83], a[92:95], v[248:251], v[80:83]
    v_fma_f32 v72, v72, s38, -v18
    v_fma_f32 v73, v73, s38, -v18
    v_mfma_f32_16x16x32_bf16 v[80:83], a[88:91], v[244:247], v[80:83]
    ds_read_b128 v[212:215], v2 offset:768
    v_med3_f32 v72, v72, -s33, s33
    v_mfma_f32_16x16x32_bf16 v[80:83], a[84:87], v[240:243], v[80:83]
    v_exp_f32 v68, v68
    v_mfma_f32_16x16x32_bf16 v[84:87], a[48:51], v[244:247], v[84:87]
    v_med3_f32 v73, v73, -s33, s33
    v_fma_f32 v74, v74, s38, -v18
    v_mfma_f32_16x16x32_bf16 v[84:87], a[52:55], v[248:251], v[84:87]
    ds_read_b128 v[152:155], v1 offset:33536
    v_med3_f32 v74, v74, -s33, s33
    v_mfma_f32_16x16x32_bf16 v[84:87], a[56:59], a[240:243], v[84:87]
    v_exp_f32 v76, v76
    v_mfma_f32_16x16x32_bf16 v[84:87], a[96:99], v[204:207], v[84:87]
    v_add_f32 v76, 1.0, v76
    v_fma_f32 v80, v80, s48, v19
    v_mfma_f32_16x16x32_bf16 v[84:87], a[100:103], v[188:191], v[84:87]
    s_waitcnt lgkmcnt(2)
    ds_read_b128 v[172:175], v2 offset:33536
    v_fmac_f32 v76, v68, v76
    v_mfma_f32_16x16x32_bf16 v[84:87], a[104:107], v[192:195], v[84:87]
    v_rcp_f32 v76, v76
    v_mfma_f32_16x16x32_bf16 v[84:87], a[144:147], v[224:227], v[84:87]
    v_fma_f32 v76, -v68, v76, v76
    v_fma_f32 v81, v81, s48, v19
    v_mfma_f32_16x16x32_bf16 v[84:87], a[148:151], v[208:211], v[84:87]
    s_waitcnt lgkmcnt(2)
    v_exp_f32 v69, v69
    v_mfma_f32_16x16x32_bf16 v[84:87], a[152:155], v[212:215], v[84:87]
    v_fma_f32 v82, v82, s48, v19
    v_fma_f32 v75, v75, s38, -v18
    v_mfma_f32_16x16x32_bf16 v[84:87], a[192:195], v[164:167], v[84:87]
    v_exp_f32 v77, v77
    v_mfma_f32_16x16x32_bf16 v[84:87], a[196:199], v[148:151], v[84:87]
    s_waitcnt lgkmcnt(1)
    v_add_f32 v77, 1.0, v77
    v_med3_f32 v75, v75, -s33, s33
    v_mfma_f32_16x16x32_bf16 v[84:87], a[200:203], v[152:155], v[84:87]
    v_exp_f32 v70, v70
    v_mfma_f32_16x16x32_bf16 v[84:87], a[0:3], v[184:187], v[84:87]
    v_fmac_f32 v77, v69, v77
    v_fma_f32 v83, v83, s48, v19
    v_mfma_f32_16x16x32_bf16 v[84:87], a[4:7], v[168:171], v[84:87]
    s_waitcnt lgkmcnt(0)
    v_rcp_f32 v77, v77
    v_mfma_f32_16x16x32_bf16 v[84:87], a[8:11], v[172:175], v[84:87]
    v_exp_f32 v78, v78
    v_mfma_f32_16x16x32_bf16 v[92:95], a[32:35], v[172:175], v[92:95]
    v_exp_f32 v71, v71
    v_mfma_f32_16x16x32_bf16 v[92:95], a[28:31], v[168:171], v[92:95]
    v_fma_f32 v77, -v69, v77, v77
    v_add_f32 v78, 1.0, v78
    v_mfma_f32_16x16x32_bf16 v[92:95], a[24:27], v[184:187], v[92:95]
    v_exp_f32 v79, v79
    v_mfma_f32_16x16x32_bf16 v[92:95], a[224:227], v[152:155], v[92:95]
    v_fmac_f32 v78, v70, v78
    v_add_f32 v79, 1.0, v79
    v_mfma_f32_16x16x32_bf16 v[92:95], a[220:223], v[148:151], v[92:95]
    v_rcp_f32 v78, v78
    v_mfma_f32_16x16x32_bf16 v[92:95], a[216:219], v[164:167], v[92:95]
    v_fma_f32 v78, -v70, v78, v78
    v_fmac_f32 v79, v71, v79
    v_mfma_f32_16x16x32_bf16 v[92:95], a[176:179], v[212:215], v[92:95]
    v_rcp_f32 v79, v79
    v_mfma_f32_16x16x32_bf16 v[92:95], a[172:175], v[208:211], v[92:95]
    v_fma_f32 v79, -v71, v79, v79
    v_cvt_pk_bf16_f32 v68, v76, v77
    v_mfma_f32_16x16x32_bf16 v[92:95], a[168:171], v[224:227], v[92:95]
    v_exp_f32 v72, v72
    v_mfma_f32_16x16x32_bf16 v[92:95], a[128:131], v[192:195], v[92:95]
    v_cvt_pk_bf16_f32 v69, v78, v79
    v_fma_f32 v84, v84, s38, -v18
    v_mfma_f32_16x16x32_bf16 v[92:95], a[124:127], v[188:191], v[92:95]
    v_exp_f32 v80, v80
    v_mfma_f32_16x16x32_bf16 v[92:95], a[120:123], v[204:207], v[92:95]
    v_add_f32 v80, 1.0, v80
    v_med3_f32 v84, v84, -s33, s33
    v_mfma_f32_16x16x32_bf16 v[92:95], a[80:83], a[240:243], v[92:95]
    v_exp_f32 v73, v73
    v_mfma_f32_16x16x32_bf16 v[92:95], a[76:79], v[248:251], v[92:95]
    v_fmac_f32 v80, v72, v80
    v_fma_f32 v85, v85, s38, -v18
    v_mfma_f32_16x16x32_bf16 v[92:95], a[72:75], v[244:247], v[92:95]
    v_rcp_f32 v80, v80
    v_mfma_f32_16x16x32_bf16 v[88:91], a[60:63], v[244:247], v[88:91]
    v_fma_f32 v80, -v72, v80, v80
    v_med3_f32 v85, v85, -s33, s33
    v_mfma_f32_16x16x32_bf16 v[88:91], a[64:67], v[248:251], v[88:91]
    v_exp_f32 v81, v81
    v_mfma_f32_16x16x32_bf16 v[88:91], a[68:71], a[240:243], v[88:91]
    v_add_f32 v81, 1.0, v81
    v_fma_f32 v92, v92, s48, v19
    v_mfma_f32_16x16x32_bf16 v[88:91], a[108:111], v[204:207], v[88:91]
    v_exp_f32 v74, v74
    v_mfma_f32_16x16x32_bf16 v[88:91], a[112:115], v[188:191], v[88:91]
    v_fmac_f32 v81, v73, v81
    v_fma_f32 v93, v93, s48, v19
    v_mfma_f32_16x16x32_bf16 v[88:91], a[116:119], v[192:195], v[88:91]
    v_rcp_f32 v81, v81
    v_mfma_f32_16x16x32_bf16 v[88:91], a[156:159], v[224:227], v[88:91]
    v_fma_f32 v81, -v73, v81, v81
    v_fma_f32 v86, v86, s38, -v18
    v_mfma_f32_16x16x32_bf16 v[88:91], a[160:163], v[208:211], v[88:91]
    v_exp_f32 v82, v82
    v_mfma_f32_16x16x32_bf16 v[88:91], a[164:167], v[212:215], v[88:91]
    v_add_f32 v82, 1.0, v82
    v_cvt_pk_bf16_f32 v70, v80, v81
    v_mfma_f32_16x16x32_bf16 v[88:91], a[204:207], v[164:167], v[88:91]
    v_exp_f32 v75, v75
    v_mfma_f32_16x16x32_bf16 v[88:91], a[208:211], v[148:151], v[88:91]
    v_fmac_f32 v82, v74, v82
    v_med3_f32 v86, v86, -s33, s33
    v_mfma_f32_16x16x32_bf16 v[88:91], a[212:215], v[152:155], v[88:91]
    v_rcp_f32 v82, v82
    v_mfma_f32_16x16x32_bf16 v[88:91], a[12:15], v[184:187], v[88:91]
    v_fma_f32 v82, -v74, v82, v82
    v_fma_f32 v94, v94, s48, v19
    v_mfma_f32_16x16x32_bf16 v[88:91], a[16:19], v[168:171], v[88:91]
    v_exp_f32 v83, v83
    v_mfma_f32_16x16x32_bf16 v[88:91], a[20:23], v[172:175], v[88:91]
    v_add_f32 v83, 1.0, v83
    v_fma_f32 v87, v87, s38, -v18
    v_mfma_f32_16x16x32_bf16 v[96:99], a[44:47], v[172:175], v[96:99]
    v_permlane16_swap_b32 v68, v70
    v_mfma_f32_16x16x32_bf16 v[96:99], a[40:43], v[168:171], v[96:99]
    v_fmac_f32 v83, v75, v83
    v_med3_f32 v87, v87, -s33, s33
    v_mfma_f32_16x16x32_bf16 v[96:99], a[36:39], v[184:187], v[96:99]
    v_rcp_f32 v83, v83
    v_mfma_f32_16x16x32_bf16 v[96:99], a[236:239], v[152:155], v[96:99]
    v_fma_f32 v83, -v75, v83, v83
    v_fma_f32 v95, v95, s48, v19
    v_mfma_f32_16x16x32_bf16 v[96:99], a[232:235], v[148:151], v[96:99]
    v_cvt_pk_bf16_f32 v71, v82, v83
    v_fma_f32 v88, v88, s38, -v18
    v_mfma_f32_16x16x32_bf16 v[96:99], a[228:231], v[164:167], v[96:99]
    v_permlane16_swap_b32 v69, v71
    v_mfma_f32_16x16x32_bf16 v[96:99], a[188:191], v[212:215], v[96:99]
    buffer_store_dwordx4 v[68:71], v12, s[20:23], 0 offen offset:2048 sc1
    v_med3_f32 v88, v88, -s33, s33
    v_mfma_f32_16x16x32_bf16 v[96:99], a[184:187], v[208:211], v[96:99]
    v_fma_f32 v89, v89, s38, -v18
    v_fma_f32 v90, v90, s38, -v18
    v_mfma_f32_16x16x32_bf16 v[96:99], a[180:183], v[224:227], v[96:99]
    v_exp_f32 v84, v84
    v_mfma_f32_16x16x32_bf16 v[96:99], a[140:143], v[192:195], v[96:99]
    v_med3_f32 v89, v89, -s33, s33
    v_med3_f32 v90, v90, -s33, s33
    v_mfma_f32_16x16x32_bf16 v[96:99], a[136:139], v[188:191], v[96:99]
    ds_read_b128 v[196:199], v1 offset:2816
    v_fma_f32 v91, v91, s38, -v18
    v_mfma_f32_16x16x32_bf16 v[96:99], a[132:135], v[204:207], v[96:99]
    v_exp_f32 v92, v92
    v_mfma_f32_16x16x32_bf16 v[96:99], a[92:95], a[240:243], v[96:99]
    v_add_f32 v92, 1.0, v92
    v_med3_f32 v91, v91, -s33, s33
    v_mfma_f32_16x16x32_bf16 v[96:99], a[88:91], v[248:251], v[96:99]
    ds_read_b128 v[216:219], v2 offset:2816
    v_fmac_f32 v92, v84, v92
    v_mfma_f32_16x16x32_bf16 v[96:99], a[84:87], v[244:247], v[96:99]
    v_rcp_f32 v92, v92
    v_mfma_f32_16x16x32_bf16 v[100:103], a[48:51], v[248:251], v[100:103]
    v_exp_f32 v85, v85
    v_mfma_f32_16x16x32_bf16 v[100:103], a[52:55], a[240:243], v[100:103]
    ds_read_b128 v[156:159], v1 offset:35584
    v_fma_f32 v92, -v84, v92, v92
    v_mfma_f32_16x16x32_bf16 v[100:103], a[56:59], a[244:247], v[100:103]
    v_exp_f32 v93, v93
    v_mfma_f32_16x16x32_bf16 v[100:103], a[96:99], v[188:191], v[100:103]
    v_add_f32 v93, 1.0, v93
    v_fma_f32 v96, v96, s48, v19
    v_mfma_f32_16x16x32_bf16 v[100:103], a[100:103], v[192:195], v[100:103]
    s_waitcnt lgkmcnt(2)
    ds_read_b128 v[176:179], v2 offset:35584
    v_fmac_f32 v93, v85, v93
    v_mfma_f32_16x16x32_bf16 v[100:103], a[104:107], v[196:199], v[100:103]
    v_rcp_f32 v93, v93
    v_mfma_f32_16x16x32_bf16 v[100:103], a[144:147], v[208:211], v[100:103]
    v_fma_f32 v93, -v85, v93, v93
    v_fma_f32 v97, v97, s48, v19
    v_mfma_f32_16x16x32_bf16 v[100:103], a[148:151], v[212:215], v[100:103]
    s_waitcnt lgkmcnt(2)
    v_exp_f32 v86, v86
    v_mfma_f32_16x16x32_bf16 v[100:103], a[152:155], v[216:219], v[100:103]
    v_fma_f32 v98, v98, s48, v19
    v_fma_f32 v99, v99, s48, v19
    v_mfma_f32_16x16x32_bf16 v[100:103], a[192:195], v[148:151], v[100:103]
    v_exp_f32 v94, v94
    v_mfma_f32_16x16x32_bf16 v[100:103], a[196:199], v[152:155], v[100:103]
    s_waitcnt lgkmcnt(1)
    v_add_f32 v94, 1.0, v94
    v_cvt_pk_bf16_f32 v84, v92, v93
    v_mfma_f32_16x16x32_bf16 v[100:103], a[200:203], v[156:159], v[100:103]
    v_exp_f32 v87, v87
    v_mfma_f32_16x16x32_bf16 v[100:103], a[0:3], v[168:171], v[100:103]
    v_exp_f32 v95, v95
    v_mfma_f32_16x16x32_bf16 v[100:103], a[4:7], v[172:175], v[100:103]
    s_waitcnt lgkmcnt(0)
    v_exp_f32 v88, v88
    v_mfma_f32_16x16x32_bf16 v[100:103], a[8:11], v[176:179], v[100:103]
    v_fmac_f32 v94, v86, v94
    v_add_f32 v95, 1.0, v95
    v_mfma_f32_16x16x32_bf16 v[108:111], a[32:35], v[176:179], v[108:111]
    v_rcp_f32 v94, v94
    v_mfma_f32_16x16x32_bf16 v[108:111], a[28:31], v[172:175], v[108:111]
    v_fma_f32 v94, -v86, v94, v94
    v_fmac_f32 v95, v87, v95
    v_mfma_f32_16x16x32_bf16 v[108:111], a[24:27], v[168:171], v[108:111]
    v_rcp_f32 v95, v95
    v_mfma_f32_16x16x32_bf16 v[108:111], a[224:227], v[156:159], v[108:111]
    v_fma_f32 v95, -v87, v95, v95
    v_fma_f32 v100, v100, s38, -v18
    v_mfma_f32_16x16x32_bf16 v[108:111], a[220:223], v[152:155], v[108:111]
    v_exp_f32 v96, v96
    v_mfma_f32_16x16x32_bf16 v[108:111], a[216:219], v[148:151], v[108:111]
    v_add_f32 v96, 1.0, v96
    v_cvt_pk_bf16_f32 v85, v94, v95
    v_mfma_f32_16x16x32_bf16 v[108:111], a[176:179], v[216:219], v[108:111]
    v_exp_f32 v89, v89
    v_mfma_f32_16x16x32_bf16 v[108:111], a[172:175], v[212:215], v[108:111]
    v_fmac_f32 v96, v88, v96
    v_med3_f32 v100, v100, -s33, s33
    v_mfma_f32_16x16x32_bf16 v[108:111], a[168:171], v[208:211], v[108:111]
    v_rcp_f32 v96, v96
    v_mfma_f32_16x16x32_bf16 v[108:111], a[128:131], v[196:199], v[108:111]
    v_fma_f32 v96, -v88, v96, v96
    v_fma_f32 v101, v101, s38, -v18
    v_mfma_f32_16x16x32_bf16 v[108:111], a[124:127], v[192:195], v[108:111]
    v_exp_f32 v97, v97
    v_mfma_f32_16x16x32_bf16 v[108:111], a[120:123], v[188:191], v[108:111]
    v_add_f32 v97, 1.0, v97
    v_med3_f32 v101, v101, -s33, s33
    v_mfma_f32_16x16x32_bf16 v[108:111], a[80:83], a[244:247], v[108:111]
    v_exp_f32 v90, v90
    v_mfma_f32_16x16x32_bf16 v[108:111], a[76:79], a[240:243], v[108:111]
    v_fmac_f32 v97, v89, v97
    v_fma_f32 v102, v102, s38, -v18
    v_mfma_f32_16x16x32_bf16 v[108:111], a[72:75], v[248:251], v[108:111]
    v_rcp_f32 v97, v97
    v_mfma_f32_16x16x32_bf16 v[104:107], a[60:63], v[248:251], v[104:107]
    v_fma_f32 v97, -v89, v97, v97
    v_med3_f32 v102, v102, -s33, s33
    v_mfma_f32_16x16x32_bf16 v[104:107], a[64:67], a[240:243], v[104:107]
    v_exp_f32 v98, v98
    v_mfma_f32_16x16x32_bf16 v[104:107], a[68:71], a[244:247], v[104:107]
    v_add_f32 v98, 1.0, v98
    v_cvt_pk_bf16_f32 v86, v96, v97
    v_mfma_f32_16x16x32_bf16 v[104:107], a[108:111], v[188:191], v[104:107]
    v_exp_f32 v91, v91
    v_mfma_f32_16x16x32_bf16 v[104:107], a[112:115], v[192:195], v[104:107]
    v_fmac_f32 v98, v90, v98
    v_fma_f32 v108, v108, s48, v19
    v_mfma_f32_16x16x32_bf16 v[104:107], a[116:119], v[196:199], v[104:107]
    v_rcp_f32 v98, v98
    v_mfma_f32_16x16x32_bf16 v[104:107], a[156:159], v[208:211], v[104:107]
    v_fma_f32 v98, -v90, v98, v98
    v_fma_f32 v109, v109, s48, v19
    v_mfma_f32_16x16x32_bf16 v[104:107], a[160:163], v[212:215], v[104:107]
    v_exp_f32 v99, v99
    v_mfma_f32_16x16x32_bf16 v[104:107], a[164:167], v[216:219], v[104:107]
    v_add_f32 v99, 1.0, v99
    v_fma_f32 v110, v110, s48, v19
    v_mfma_f32_16x16x32_bf16 v[104:107], a[204:207], v[148:151], v[104:107]
    v_permlane16_swap_b32 v84, v86
    v_mfma_f32_16x16x32_bf16 v[104:107], a[208:211], v[152:155], v[104:107]
    v_fmac_f32 v99, v91, v99
    v_fma_f32 v103, v103, s38, -v18
    v_mfma_f32_16x16x32_bf16 v[104:107], a[212:215], v[156:159], v[104:107]
    v_rcp_f32 v99, v99
    v_mfma_f32_16x16x32_bf16 v[104:107], a[12:15], v[168:171], v[104:107]
    v_fma_f32 v99, -v91, v99, v99
    v_med3_f32 v103, v103, -s33, s33
    v_mfma_f32_16x16x32_bf16 v[104:107], a[16:19], v[172:175], v[104:107]
    v_cvt_pk_bf16_f32 v87, v98, v99
    v_fma_f32 v111, v111, s48, v19
    v_mfma_f32_16x16x32_bf16 v[104:107], a[20:23], v[176:179], v[104:107]
    v_permlane16_swap_b32 v85, v87
    v_mfma_f32_16x16x32_bf16 v[112:115], a[44:47], v[176:179], v[112:115]
    buffer_store_dwordx4 v[84:87], v13, s[20:23], 0 offen offset:0 sc1
    v_mfma_f32_16x16x32_bf16 v[112:115], a[40:43], v[172:175], v[112:115]
    v_exp_f32 v100, v100
    v_mfma_f32_16x16x32_bf16 v[112:115], a[36:39], v[168:171], v[112:115]
    v_exp_f32 v108, v108
    v_mfma_f32_16x16x32_bf16 v[112:115], a[236:239], v[156:159], v[112:115]
    v_add_f32 v108, 1.0, v108
    v_fma_f32 v104, v104, s38, -v18
    v_mfma_f32_16x16x32_bf16 v[112:115], a[232:235], v[152:155], v[112:115]
    v_exp_f32 v101, v101
    v_mfma_f32_16x16x32_bf16 v[112:115], a[228:231], v[148:151], v[112:115]
    v_fmac_f32 v108, v100, v108
    v_med3_f32 v104, v104, -s33, s33
    v_mfma_f32_16x16x32_bf16 v[112:115], a[188:191], v[216:219], v[112:115]
    v_rcp_f32 v108, v108
    v_mfma_f32_16x16x32_bf16 v[112:115], a[184:187], v[212:215], v[112:115]
    v_fma_f32 v108, -v100, v108, v108
    v_fma_f32 v105, v105, s38, -v18
    v_mfma_f32_16x16x32_bf16 v[112:115], a[180:183], v[208:211], v[112:115]
    v_exp_f32 v109, v109
    v_mfma_f32_16x16x32_bf16 v[112:115], a[140:143], v[196:199], v[112:115]
    v_add_f32 v109, 1.0, v109
    v_med3_f32 v105, v105, -s33, s33
    v_mfma_f32_16x16x32_bf16 v[112:115], a[136:139], v[192:195], v[112:115]
    ds_read_b128 v[200:203], v3 offset:0
    v_fmac_f32 v109, v101, v109
    v_mfma_f32_16x16x32_bf16 v[112:115], a[132:135], v[188:191], v[112:115]
L_pg4:
    s_cmp_eq_u32 s30, 1
    s_cbranch_scc1 L_warm_ret
    v_rcp_f32 v109, v109
    v_mfma_f32_16x16x32_bf16 v[112:115], a[92:95], a[244:247], v[112:115]
    v_fma_f32 v109, -v101, v109, v109
    v_fma_f32 v106, v106, s38, -v18
    v_mfma_f32_16x16x32_bf16 v[112:115], a[88:91], a[240:243], v[112:115]
    ds_read_b128 v[220:223], v4 offset:0
    v_med3_f32 v106, v106, -s33, s33
    v_mfma_f32_16x16x32_bf16 v[112:115], a[84:87], v[248:251], v[112:115]
    v_exp_f32 v102, v102
    v_mfma_f32_16x16x32_bf16 v[116:119], a[48:51], a[240:243], v[116:119]
    v_fma_f32 v107, v107, s38, -v18
    v_cvt_pk_bf16_f32 v100, v108, v109
    v_mfma_f32_16x16x32_bf16 v[116:119], a[52:55], a[244:247], v[116:119]
    ds_read_b128 v[160:163], v3 offset:32768
    v_med3_f32 v107, v107, -s33, s33
    v_mfma_f32_16x16x32_bf16 v[116:119], a[56:59], a[248:251], v[116:119]
    v_exp_f32 v110, v110
    v_mfma_f32_16x16x32_bf16 v[116:119], a[96:99], v[192:195], v[116:119]
    v_add_f32 v110, 1.0, v110
    v_fma_f32 v112, v112, s48, v19
    v_mfma_f32_16x16x32_bf16 v[116:119], a[100:103], v[196:199], v[116:119]
    s_waitcnt lgkmcnt(2)
    ds_read_b128 v[180:183], v4 offset:32768
    v_fmac_f32 v110, v102, v110
    v_mfma_f32_16x16x32_bf16 v[116:119], a[104:107], v[200:203], v[116:119]
    v_rcp_f32 v110, v110
    v_mfma_f32_16x16x32_bf16 v[116:119], a[144:147], v[212:215], v[116:119]
    v_fma_f32 v110, -v102, v110, v110
    v_fma_f32 v113, v113, s48, v19
    v_mfma_f32_16x16x32_bf16 v[116:119], a[148:151], v[216:219], v[116:119]
    s_waitcnt lgkmcnt(2)
    v_exp_f32 v103, v103
    v_mfma_f32_16x16x32_bf16 v[116:119], a[152:155], v[220:223], v[116:119]
    v_fma_f32 v114, v114, s48, v19
    v_fma_f32 v115, v115, s48, v19
    v_mfma_f32_16x16x32_bf16 v[116:119], a[192:195], v[152:155], v[116:119]
    v_exp_f32 v111, v111
    v_mfma_f32_16x16x32_bf16 v[116:119], a[196:199], v[156:159], v[116:119]
    s_waitcnt lgkmcnt(1)
    v_exp_f32 v104, v104
    v_mfma_f32_16x16x32_bf16 v[116:119], a[200:203], v[160:163], v[116:119]
    v_exp_f32 v112, v112
    v_mfma_f32_16x16x32_bf16 v[116:119], a[0:3], v[172:175], v[116:119]
    v_add_f32 v111, 1.0, v111
    v_add_f32 v112, 1.0, v112
    v_mfma_f32_16x16x32_bf16 v[116:119], a[4:7], v[176:179], v[116:119]
    s_waitcnt lgkmcnt(0)
    v_exp_f32 v105, v105
    v_mfma_f32_16x16x32_bf16 v[116:119], a[8:11], v[180:183], v[116:119]
    v_fmac_f32 v111, v103, v111
    v_fmac_f32 v112, v104, v112
    v_mfma_f32_16x16x32_bf16 v[124:127], a[32:35], v[180:183], v[124:127]
    v_rcp_f32 v111, v111
    v_mfma_f32_16x16x32_bf16 v[124:127], a[28:31], v[176:179], v[124:127]
    v_rcp_f32 v112, v112
    v_mfma_f32_16x16x32_bf16 v[124:127], a[24:27], v[172:175], v[124:127]
    v_exp_f32 v113, v113
    v_mfma_f32_16x16x32_bf16 v[124:127], a[224:227], v[160:163], v[124:127]
    v_fma_f32 v111, -v103, v111, v111
    v_fma_f32 v112, -v104, v112, v112
    v_mfma_f32_16x16x32_bf16 v[124:127], a[220:223], v[156:159], v[124:127]
    v_exp_f32 v106, v106
    v_mfma_f32_16x16x32_bf16 v[124:127], a[216:219], v[152:155], v[124:127]
    v_add_f32 v113, 1.0, v113
    v_cvt_pk_bf16_f32 v101, v110, v111
    v_mfma_f32_16x16x32_bf16 v[124:127], a[176:179], v[220:223], v[124:127]
    v_exp_f32 v114, v114
    v_mfma_f32_16x16x32_bf16 v[124:127], a[172:175], v[216:219], v[124:127]
    v_fmac_f32 v113, v105, v113
    v_add_f32 v114, 1.0, v114
    v_mfma_f32_16x16x32_bf16 v[124:127], a[168:171], v[212:215], v[124:127]
    v_rcp_f32 v113, v113
    v_mfma_f32_16x16x32_bf16 v[124:127], a[128:131], v[200:203], v[124:127]
    v_fma_f32 v113, -v105, v113, v113
    v_fmac_f32 v114, v106, v114
    v_mfma_f32_16x16x32_bf16 v[124:127], a[124:127], v[196:199], v[124:127]
    v_rcp_f32 v114, v114
    v_mfma_f32_16x16x32_bf16 v[124:127], a[120:123], v[192:195], v[124:127]
    v_fma_f32 v114, -v106, v114, v114
    v_cvt_pk_bf16_f32 v102, v112, v113
    v_mfma_f32_16x16x32_bf16 v[124:127], a[80:83], a[248:251], v[124:127]
    v_exp_f32 v107, v107
    v_mfma_f32_16x16x32_bf16 v[124:127], a[76:79], a[244:247], v[124:127]
    v_exp_f32 v115, v115
    v_mfma_f32_16x16x32_bf16 v[124:127], a[72:75], a[240:243], v[124:127]
    v_add_f32 v115, 1.0, v115
    v_fma_f32 v116, v116, s38, -v18
    v_mfma_f32_16x16x32_bf16 v[120:123], a[60:63], a[240:243], v[120:123]
    v_permlane16_swap_b32 v100, v102
    v_mfma_f32_16x16x32_bf16 v[120:123], a[64:67], a[244:247], v[120:123]
    v_fmac_f32 v115, v107, v115
    v_med3_f32 v116, v116, -s33, s33
    v_mfma_f32_16x16x32_bf16 v[120:123], a[68:71], a[248:251], v[120:123]
    v_rcp_f32 v115, v115
    v_mfma_f32_16x16x32_bf16 v[120:123], a[108:111], v[192:195], v[120:123]
    v_fma_f32 v115, -v107, v115, v115
    v_fma_f32 v124, v124, s48, v19
    v_mfma_f32_16x16x32_bf16 v[120:123], a[112:115], v[196:199], v[120:123]
    v_cvt_pk_bf16_f32 v103, v114, v115
    v_fma_f32 v117, v117, s38, -v18
    v_mfma_f32_16x16x32_bf16 v[120:123], a[116:119], v[200:203], v[120:123]
    v_permlane16_swap_b32 v101, v103
    v_mfma_f32_16x16x32_bf16 v[120:123], a[156:159], v[212:215], v[120:123]
    buffer_store_dwordx4 v[100:103], v13, s[20:23], 0 offen offset:2048 sc1
    v_med3_f32 v117, v117, -s33, s33
    v_mfma_f32_16x16x32_bf16 v[120:123], a[160:163], v[216:219], v[120:123]
    v_fma_f32 v125, v125, s48, v19
    v_fma_f32 v118, v118, s38, -v18
    v_mfma_f32_16x16x32_bf16 v[120:123], a[164:167], v[220:223], v[120:123]
    v_exp_f32 v116, v116
    v_mfma_f32_16x16x32_bf16 v[120:123], a[204:207], v[152:155], v[120:123]
    v_med3_f32 v118, v118, -s33, s33
    v_fma_f32 v126, v126, s48, v19
    v_mfma_f32_16x16x32_bf16 v[120:123], a[208:211], v[156:159], v[120:123]
    v_exp_f32 v124, v124
    v_mfma_f32_16x16x32_bf16 v[120:123], a[212:215], v[160:163], v[120:123]
    v_add_f32 v124, 1.0, v124
    v_fma_f32 v119, v119, s38, -v18
    v_mfma_f32_16x16x32_bf16 v[120:123], a[12:15], v[172:175], v[120:123]
    v_exp_f32 v117, v117
    v_mfma_f32_16x16x32_bf16 v[120:123], a[16:19], v[176:179], v[120:123]
    v_fmac_f32 v124, v116, v124
    v_med3_f32 v119, v119, -s33, s33
    v_mfma_f32_16x16x32_bf16 v[120:123], a[20:23], v[180:183], v[120:123]
    v_rcp_f32 v124, v124
    v_mfma_f32_16x16x32_bf16 v[128:131], a[44:47], v[180:183], v[128:131]
    v_fma_f32 v124, -v116, v124, v124
    v_fma_f32 v127, v127, s48, v19
    v_mfma_f32_16x16x32_bf16 v[128:131], a[40:43], v[176:179], v[128:131]
    v_exp_f32 v125, v125
    v_mfma_f32_16x16x32_bf16 v[128:131], a[36:39], v[172:175], v[128:131]
    v_exp_f32 v118, v118
    v_mfma_f32_16x16x32_bf16 v[128:131], a[236:239], v[160:163], v[128:131]
    v_exp_f32 v126, v126
    v_mfma_f32_16x16x32_bf16 v[128:131], a[232:235], v[156:159], v[128:131]
    v_add_f32 v125, 1.0, v125
    v_add_f32 v126, 1.0, v126
    v_mfma_f32_16x16x32_bf16 v[128:131], a[228:231], v[152:155], v[128:131]
    v_exp_f32 v119, v119
    v_mfma_f32_16x16x32_bf16 v[128:131], a[188:191], v[220:223], v[128:131]
    v_fmac_f32 v125, v117, v125
    v_fmac_f32 v126, v118, v126
    v_mfma_f32_16x16x32_bf16 v[128:131], a[184:187], v[216:219], v[128:131]
    v_rcp_f32 v125, v125
    v_mfma_f32_16x16x32_bf16 v[128:131], a[180:183], v[212:215], v[128:131]
    v_fma_f32 v125, -v117, v125, v125
    v_fma_f32 v120, v120, s38, -v18
    v_mfma_f32_16x16x32_bf16 v[128:131], a[140:143], v[200:203], v[128:131]
    v_rcp_f32 v126, v126
    v_mfma_f32_16x16x32_bf16 v[128:131], a[136:139], v[196:199], v[128:131]
    ds_read_b128 v[204:207], v16 offset:2048
    v_fma_f32 v126, -v118, v126, v126
    v_mfma_f32_16x16x32_bf16 v[128:131], a[132:135], v[192:195], v[128:131]
    v_med3_f32 v120, v120, -s33, s33
    v_fma_f32 v121, v121, s38, -v18
    v_mfma_f32_16x16x32_bf16 v[128:131], a[92:95], a[248:251], v[128:131]
    v_exp_f32 v127, v127
    v_mfma_f32_16x16x32_bf16 v[128:131], a[88:91], a[244:247], v[128:131]
    ds_read_b128 v[224:227], v17 offset:2048
    v_add_f32 v127, 1.0, v127
    v_mfma_f32_16x16x32_bf16 v[128:131], a[84:87], a[240:243], v[128:131]
    v_fmac_f32 v127, v119, v127
    v_med3_f32 v121, v121, -s33, s33
    v_mfma_f32_16x16x32_bf16 v[132:135], a[48:51], a[244:247], v[132:135]
    v_rcp_f32 v127, v127
    v_mfma_f32_16x16x32_bf16 v[132:135], a[52:55], a[248:251], v[132:135]
    ds_read_b128 v[164:167], v16 offset:34816
    v_fma_f32 v127, -v119, v127, v127
    v_mfma_f32_16x16x32_bf16 v[132:135], a[56:59], a[252:255], v[132:135]
    v_fma_f32 v128, v128, s48, v19
    v_fma_f32 v129, v129, s48, v19
    v_mfma_f32_16x16x32_bf16 v[132:135], a[96:99], v[196:199], v[132:135]
    v_exp_f32 v120, v120
    v_mfma_f32_16x16x32_bf16 v[132:135], a[100:103], v[200:203], v[132:135]
    s_waitcnt lgkmcnt(2)
    ds_read_b128 v[184:187], v17 offset:34816
    v_fma_f32 v122, v122, s38, -v18
    v_mfma_f32_16x16x32_bf16 v[132:135], a[104:107], v[204:207], v[132:135]
    v_med3_f32 v122, v122, -s33, s33
    v_fma_f32 v130, v130, s48, v19
    v_mfma_f32_16x16x32_bf16 v[132:135], a[144:147], v[216:219], v[132:135]
    v_exp_f32 v128, v128
    v_mfma_f32_16x16x32_bf16 v[132:135], a[148:151], v[220:223], v[132:135]
    s_waitcnt lgkmcnt(2)
    v_add_f32 v128, 1.0, v128
    v_fma_f32 v123, v123, s38, -v18
    v_mfma_f32_16x16x32_bf16 v[132:135], a[152:155], v[224:227], v[132:135]
    v_exp_f32 v121, v121
    v_mfma_f32_16x16x32_bf16 v[132:135], a[192:195], v[156:159], v[132:135]
    v_fmac_f32 v128, v120, v128
    v_med3_f32 v123, v123, -s33, s33
    v_mfma_f32_16x16x32_bf16 v[132:135], a[196:199], v[160:163], v[132:135]
    s_waitcnt lgkmcnt(1)
    v_rcp_f32 v128, v128
    v_mfma_f32_16x16x32_bf16 v[132:135], a[200:203], v[164:167], v[132:135]
    v_fma_f32 v128, -v120, v128, v128
    v_fma_f32 v131, v131, s48, v19
    v_mfma_f32_16x16x32_bf16 v[132:135], a[0:3], v[176:179], v[132:135]
    v_exp_f32 v129, v129
    v_mfma_f32_16x16x32_bf16 v[132:135], a[4:7], v[180:183], v[132:135]
    s_waitcnt lgkmcnt(0)
    v_add_f32 v129, 1.0, v129
    v_cvt_pk_bf16_f32 v116, v124, v125
    v_mfma_f32_16x16x32_bf16 v[132:135], a[8:11], v[184:187], v[132:135]
    v_exp_f32 v122, v122
    v_mfma_f32_16x16x32_bf16 v[140:143], a[32:35], v[184:187], v[140:143]
    v_fmac_f32 v129, v121, v129
    v_cvt_pk_bf16_f32 v117, v126, v127
    v_mfma_f32_16x16x32_bf16 v[140:143], a[28:31], v[180:183], v[140:143]
    v_rcp_f32 v129, v129
    v_mfma_f32_16x16x32_bf16 v[140:143], a[24:27], v[176:179], v[140:143]
    v_exp_f32 v130, v130
    v_mfma_f32_16x16x32_bf16 v[140:143], a[224:227], v[164:167], v[140:143]
    v_exp_f32 v123, v123
    v_mfma_f32_16x16x32_bf16 v[140:143], a[220:223], v[160:163], v[140:143]
    v_fma_f32 v129, -v121, v129, v129
    v_add_f32 v130, 1.0, v130
    v_mfma_f32_16x16x32_bf16 v[140:143], a[216:219], v[156:159], v[140:143]
    v_exp_f32 v131, v131
    v_mfma_f32_16x16x32_bf16 v[140:143], a[176:179], v[224:227], v[140:143]
    v_fmac_f32 v130, v122, v130
    v_add_f32 v131, 1.0, v131
    v_mfma_f32_16x16x32_bf16 v[140:143], a[172:175], v[220:223], v[140:143]
    v_rcp_f32 v130, v130
    v_mfma_f32_16x16x32_bf16 v[140:143], a[168:171], v[216:219], v[140:143]
    v_fma_f32 v130, -v122, v130, v130
    v_fmac_f32 v131, v123, v131
    v_mfma_f32_16x16x32_bf16 v[140:143], a[128:131], v[204:207], v[140:143]
    v_rcp_f32 v131, v131
    v_mfma_f32_16x16x32_bf16 v[140:143], a[124:127], v[200:203], v[140:143]
    v_fma_f32 v131, -v123, v131, v131
    v_cvt_pk_bf16_f32 v118, v128, v129
    v_mfma_f32_16x16x32_bf16 v[140:143], a[120:123], v[196:199], v[140:143]
    v_cvt_pk_bf16_f32 v119, v130, v131
    v_fma_f32 v132, v132, s38, -v18
    v_mfma_f32_16x16x32_bf16 v[140:143], a[80:83], a[252:255], v[140:143]
    v_permlane16_swap_b32 v116, v118
    v_mfma_f32_16x16x32_bf16 v[140:143], a[76:79], a[248:251], v[140:143]
    v_permlane16_swap_b32 v117, v119
    v_mfma_f32_16x16x32_bf16 v[140:143], a[72:75], a[244:247], v[140:143]
    buffer_store_dwordx4 v[116:119], v14, s[20:23], 0 offen offset:0 sc1
    v_med3_f32 v132, v132, -s33, s33
    v_mfma_f32_16x16x32_bf16 v[136:139], a[60:63], a[244:247], v[136:139]
    v_fma_f32 v133, v133, s38, -v18
    v_fma_f32 v134, v134, s38, -v18
    v_mfma_f32_16x16x32_bf16 v[136:139], a[64:67], a[248:251], v[136:139]
    v_exp_f32 v132, v132
    v_mfma_f32_16x16x32_bf16 v[136:139], a[68:71], a[252:255], v[136:139]
    v_fma_f32 v140, v140, s48, v19
    v_med3_f32 v133, v133, -s33, s33
    v_mfma_f32_16x16x32_bf16 v[136:139], a[108:111], v[196:199], v[136:139]
    v_exp_f32 v140, v140
    v_mfma_f32_16x16x32_bf16 v[136:139], a[112:115], v[200:203], v[136:139]
    v_add_f32 v140, 1.0, v140
    v_fma_f32 v141, v141, s48, v19
    v_mfma_f32_16x16x32_bf16 v[136:139], a[116:119], v[204:207], v[136:139]
    v_exp_f32 v133, v133
    v_mfma_f32_16x16x32_bf16 v[136:139], a[156:159], v[216:219], v[136:139]
    v_fmac_f32 v140, v132, v140
    v_med3_f32 v134, v134, -s33, s33
    v_mfma_f32_16x16x32_bf16 v[136:139], a[160:163], v[220:223], v[136:139]
    v_rcp_f32 v140, v140
    v_mfma_f32_16x16x32_bf16 v[136:139], a[164:167], v[224:227], v[136:139]
    v_fma_f32 v140, -v132, v140, v140
    v_fma_f32 v142, v142, s48, v19
    v_mfma_f32_16x16x32_bf16 v[136:139], a[204:207], v[156:159], v[136:139]
    v_exp_f32 v141, v141
    v_mfma_f32_16x16x32_bf16 v[136:139], a[208:211], v[160:163], v[136:139]
    v_add_f32 v141, 1.0, v141
    v_fma_f32 v135, v135, s38, -v18
    v_mfma_f32_16x16x32_bf16 v[136:139], a[212:215], v[164:167], v[136:139]
    v_exp_f32 v134, v134
    v_mfma_f32_16x16x32_bf16 v[136:139], a[12:15], v[176:179], v[136:139]
    v_fmac_f32 v141, v133, v141
    v_med3_f32 v135, v135, -s33, s33
    v_mfma_f32_16x16x32_bf16 v[136:139], a[16:19], v[180:183], v[136:139]
    v_rcp_f32 v141, v141
    v_mfma_f32_16x16x32_bf16 v[136:139], a[20:23], v[184:187], v[136:139]
    v_fma_f32 v141, -v133, v141, v141
    v_fma_f32 v143, v143, s48, v19
    v_mfma_f32_16x16x32_bf16 v[144:147], a[44:47], v[184:187], v[144:147]
    v_exp_f32 v142, v142
    v_mfma_f32_16x16x32_bf16 v[144:147], a[40:43], v[180:183], v[144:147]
    v_add_f32 v142, 1.0, v142
    v_cvt_pk_bf16_f32 v132, v140, v141
    v_mfma_f32_16x16x32_bf16 v[144:147], a[36:39], v[176:179], v[144:147]
    v_exp_f32 v135, v135
    v_mfma_f32_16x16x32_bf16 v[144:147], a[236:239], v[164:167], v[144:147]
    v_fmac_f32 v142, v134, v142
    v_fma_f32 v136, v136, s38, -v18
    v_mfma_f32_16x16x32_bf16 v[144:147], a[232:235], v[160:163], v[144:147]
    v_rcp_f32 v142, v142
    v_mfma_f32_16x16x32_bf16 v[144:147], a[228:231], v[156:159], v[144:147]
    v_fma_f32 v142, -v134, v142, v142
    v_med3_f32 v136, v136, -s33, s33
    v_mfma_f32_16x16x32_bf16 v[144:147], a[188:191], v[224:227], v[144:147]
    v_exp_f32 v143, v143
    v_mfma_f32_16x16x32_bf16 v[144:147], a[184:187], v[220:223], v[144:147]
    v_add_f32 v143, 1.0, v143
    v_fma_f32 v137, v137, s38, -v18
    v_mfma_f32_16x16x32_bf16 v[144:147], a[180:183], v[216:219], v[144:147]
    v_exp_f32 v136, v136
    v_mfma_f32_16x16x32_bf16 v[144:147], a[140:143], v[204:207], v[144:147]
    v_fmac_f32 v143, v135, v143
    v_med3_f32 v137, v137, -s33, s33
    v_mfma_f32_16x16x32_bf16 v[144:147], a[136:139], v[200:203], v[144:147]
    v_rcp_f32 v143, v143
    v_mfma_f32_16x16x32_bf16 v[144:147], a[132:135], v[196:199], v[144:147]
    v_fma_f32 v143, -v135, v143, v143
    v_fma_f32 v138, v138, s38, -v18
    v_mfma_f32_16x16x32_bf16 v[144:147], a[92:95], a[252:255], v[144:147]
    v_exp_f32 v137, v137
    v_mfma_f32_16x16x32_bf16 v[144:147], a[88:91], a[248:251], v[144:147]
    v_med3_f32 v138, v138, -s33, s33
    v_fma_f32 v139, v139, s38, -v18
    v_mfma_f32_16x16x32_bf16 v[144:147], a[84:87], a[244:247], v[144:147]
    v_exp_f32 v138, v138
    v_med3_f32 v139, v139, -s33, s33
    v_exp_f32 v139, v139
    v_cvt_pk_bf16_f32 v133, v142, v143
    s_nop 3
    v_pk_fma_f32 v[144:145], v[144:145], s[48:49], v[18:19] op_sel:[0,0,1]
    v_pk_fma_f32 v[146:147], v[146:147], s[48:49], v[18:19] op_sel:[0,0,1]
    v_exp_f32 v144, v144
    v_exp_f32 v145, v145
    v_exp_f32 v146, v146
    v_exp_f32 v147, v147
    v_pk_add_f32 v[144:145], v[144:145], 1.0 op_sel_hi:[1,0]
    v_pk_add_f32 v[146:147], v[146:147], 1.0 op_sel_hi:[1,0]
    v_pk_fma_f32 v[144:145], v[136:137], v[144:145], v[144:145]
    v_pk_fma_f32 v[146:147], v[138:139], v[146:147], v[146:147]
    v_rcp_f32 v144, v144
    v_rcp_f32 v145, v145
    v_rcp_f32 v146, v146
    v_rcp_f32 v147, v147
    v_pk_fma_f32 v[144:145], v[136:137], v[144:145], v[144:145] neg_lo:[1,0,0] neg_hi:[1,0,0]
    v_pk_fma_f32 v[146:147], v[138:139], v[146:147], v[146:147] neg_lo:[1,0,0] neg_hi:[1,0,0]
    v_cvt_pk_bf16_f32 v134, v144, v145
    v_cvt_pk_bf16_f32 v135, v146, v147
    s_nop 0
    v_permlane16_swap_b32 v132, v134
    v_permlane16_swap_b32 v133, v135
    buffer_store_dwordx4 v[132:135], v14, s[20:23], 0 offen offset:2048 sc1
L_end:
    s_endpgm
.p2alignl 12, 0xbf810000
L_text_end:
.section .rodata,"a"
.p2align 6
.amdhsa_kernel standalone__autoregressive_conv_wavernn__speech_kernel
  .amdhsa_next_free_vgpr 512
  .amdhsa_next_free_sgpr 102
  .amdhsa_accum_offset 256
  .amdhsa_group_segment_fixed_size 0
  .amdhsa_kernarg_size 40
  .amdhsa_user_sgpr_count 2
  .amdhsa_user_sgpr_kernarg_segment_ptr 1
  .amdhsa_system_sgpr_workgroup_id_x 1
.end_amdhsa_kernel
```
